```python
import torch

def _softmax(x, axis=-1):
    return torch.softmax(x, dim=axis)
def _gelu(x):
    return torch.nn.functional.gelu(x, approximate="tanh")
def _silu(x):
    return torch.nn.functional.silu(x)
def _sigmoid(x):
    return torch.sigmoid(x)
def _layernorm(x, axis=-1, eps=1e-5):
    m = x.mean(dim=axis, keepdim=True)
    v = x.var(dim=axis, keepdim=True, unbiased=False)
    return (x - m) / torch.sqrt(v + eps)
def _scatter_add(tgt, idx, src, axis=0):
    return tgt.clone().index_add_(axis, idx, src)
def _segment_sum(src, seg, n):
    out = torch.zeros((n,) + src.shape[1:], dtype=src.dtype)
    return out.index_add_(0, seg, src)
def _pad(x, pw):
    flat = tuple(v for pair in reversed(pw) for v in pair)
    return torch.nn.functional.pad(x, flat)

kernel_name = 'concat_heads__mha_block__ssm_conv_s4__prompt'

def setup_inputs():

    _w = (lambda a: (lambda t: t.to(torch.bfloat16) if t.is_floating_point() else t)(torch.as_tensor(a)))
    def _A_setup():
        B, S, D, H = 1, 2048, 640, 32
        return {
            "x": _w((lambda *s: torch.randn(*s, dtype=torch.bfloat16) * 0.2)(B, S, D)),
            "wqkv": _w((lambda *s: torch.randn(*s, dtype=torch.bfloat16) * 0.2)(D, 3 * D)),
            "wo": _w((lambda *s: torch.randn(*s, dtype=torch.bfloat16) * 0.05)(D, D)),
        }
    _A_in = _A_setup()

    def _B_setup():
        B, L, D, N = 1, 2048, 640, 128
        A_re = -(lambda _x: torch.exp(torch.as_tensor(_x)))((lambda *s: torch.randn(*s, dtype=torch.bfloat16) * 3.2)(D, N))
        A_im = torch.pi * (lambda *s: torch.randn(*s, dtype=torch.bfloat16) * 0.1)(D, N)
        B_re = (lambda *s: torch.randn(*s, dtype=torch.bfloat16) * 0.4)(D, N)
        B_im = (lambda *s: torch.randn(*s, dtype=torch.bfloat16) * 0.4)(D, N)
        C_re = (lambda *s: torch.randn(*s, dtype=torch.bfloat16) * 0.4)(D, N)
        C_im = (lambda *s: torch.randn(*s, dtype=torch.bfloat16) * 0.4)(D, N)
        log_dt = (lambda *s: torch.randn(*s, dtype=torch.bfloat16) * 0.1)(D) * 0.5 - 4.0
        Dskip = (lambda *s: torch.randn(*s, dtype=torch.bfloat16) * 0.2)(D)
        return {
            "u": _w((lambda *s: torch.randn(*s, dtype=torch.bfloat16) * 0.05)(B, L, D)),
            "A_re": _w(A_re),
            "A_im": _w(A_im),
            "B_re": _w(B_re),
            "B_im": _w(B_im),
            "C_re": _w(C_re),
            "C_im": _w(C_im),
            "log_dt": _w(log_dt),
            "Dskip": _w(Dskip),
        }
    _B_in = _B_setup()

    return {
        "A_x": _A_in["x"],
        "A_wqkv": _A_in["wqkv"],
        "A_wo": _A_in["wo"],
        "B_u": _B_in["u"],
        "B_A_re": _B_in["A_re"],
        "B_A_im": _B_in["A_im"],
        "B_B_re": _B_in["B_re"],
        "B_B_im": _B_in["B_im"],
        "B_C_re": _B_in["C_re"],
        "B_C_im": _B_in["C_im"],
        "B_log_dt": _B_in["log_dt"],
        "B_Dskip": _B_in["Dskip"],
    }

def reference(A_x, A_wqkv, A_wo, B_u, B_A_re, B_A_im, B_B_re, B_B_im, B_C_re, B_C_im, B_log_dt, B_Dskip):
    def _A_ref(x, wqkv, wo):
        B, S, D = x.shape
        H = 32
        Dh = D // H
        qkv = (lambda x, *d: x.permute(*d))((x @ wqkv).reshape(B, S, 3, H, Dh), 2, 0, 3, 1, 4)
        q, k, v = qkv[0], qkv[1], qkv[2]
        scores = torch.einsum("bhqd,bhkd->bhqk", q, k) * (Dh ** -0.5)
        p = _softmax(scores, axis=-1)
        o = torch.einsum("bhqk,bhkd->bhqd", p, v)
        return (lambda x, *d: x.permute(*d))(o, 0, 2, 1, 3).reshape(B, S, D) @ wo

    def _B_ref(u, A_re, A_im, B_re, B_im, C_re, C_im, log_dt, Dskip):
        Bsz, L, D = u.shape
        dt = torch.exp(log_dt)[:, None]
        A = A_re + 1j * A_im
        Bc = B_re + 1j * B_im
        Cc = C_re + 1j * C_im
        logdA = dt * A
        dB = dt * Bc
        l = (lambda x, dt: x.to(dt))(torch.arange(L), A_re.dtype)
        P = torch.exp(logdA[:, :, None] * l[None, None, :])
        K = torch.einsum("dn,dnl,dn->dl", Cc, P, dB).real
        L2 = 2 * L
        Kp = _pad(K, ((0, 0), (0, L)))
        up = (lambda x, *d: x.permute(*d))(u, 0, 2, 1)
        up = _pad(up, ((0, 0), (0, 0), (0, L)))
        Kf = (lambda x, axes=(-2,-1): torch.fft.rfft2(x.float(), dim=axes))(Kp[:, None, :], axes=(-2, -1))
        Uf = (lambda x, axes=(-2,-1): torch.fft.rfft2(x.float(), dim=axes))(up[:, :, None, :], axes=(-2, -1))
        Yf = Uf * Kf[None, :, :, :]
        y = (lambda x, s, axes=(-2,-1): torch.fft.irfft2(x, s=s, dim=axes).to(torch.bfloat16))(Yf, (1, L2), axes=(-2, -1))[:, :, 0, :L]
        y = (lambda x, *d: x.permute(*d))(y, 0, 2, 1) + u * Dskip[None, None, :]
        return y

    a = _A_ref(A_x, A_wqkv, A_wo)
    b = _B_ref(B_u, B_A_re, B_A_im, B_B_re, B_B_im, B_C_re, B_C_im, B_log_dt, B_Dskip)
    return torch.concatenate([a, b], axis=-1)
```

```asm
; @launch kernel=qkv_kernel grid=(256,1,1) block=(512,1,1) lds=163840
; @launch kernel=attn_kernel grid=(256,1,1) block=(768,1,1) lds=163840
.amdgcn_target "amdgcn-amd-amdhsa--gfx950"
.text
.globl qkv_kernel
.p2align 8
.type qkv_kernel,@function
qkv_kernel:
    s_cmp_ge_u32 s2, 256
    s_cbranch_scc1 L_qkv_kernel_done_x
    s_getpc_b64 s[96:97]
L_qkv_kernel_pc:
    v_lshlrev_b32 v1, 6, v0
    v_min_u32 v1, L_qkv_kernel_end-L_qkv_kernel_pc-4, v1
    global_load_dword v176, v1, s[96:97]
    s_load_dwordx16 s[8:23], s[0:1], 0
    s_load_dwordx8 s[24:31], s[0:1], 64
    s_load_dwordx2 s[32:33], s[0:1], 112
    v_lshrrev_b32 v2, 6, v0
    s_cmp_lt_u32 s2, 240
    s_cselect_b64 vcc, -1, 0
    v_readfirstlane_b32 s3, v2
    s_cselect_b32 s4, 4, 0
    s_cmp_ge_u32 s3, s4
    s_cbranch_scc1 L_p1_aux
    s_setprio 2
    s_and_b32 s50, s2, 7
    s_lshr_b32 s51, s2, 3
    s_and_b32 s52, s51, 1
    s_lshl_b32 s48, s50, 1
    s_add_u32 s48, s48, s52
    s_lshr_b32 s49, s51, 1
    v_and_b32 v1, 63, v0
    v_lshrrev_b32 v22, 3, v1
    v_mul_u32_u24 v22, 1280, v22
    v_and_b32 v23, 7, v1
    v_lshrrev_b32 v24, 4, v1
    v_xor_b32 v23, v23, v24
    v_lshlrev_b32 v23, 4, v23
    v_xor_b32 v25, 64, v23
    s_lshl_b32 s50, s48, 2
    s_add_u32 s50, s50, s3
    s_mul_i32 s50, s50, 40960
    v_add_u32 v22, s50, v22
    v_add_u32 v2, v22, v23
    v_add_u32 v3, v22, v25
    v_add_u32 v4, 18432, v2
    v_add_u32 v5, 27648, v3
    v_add_u32 v3, 9216, v3
    v_mul_u32_u24 v22, 3840, v24
    v_and_b32 v23, 15, v1
    v_lshlrev_b32 v25, 2, v24
    v_xor_b32 v23, v23, v25
    v_lshlrev_b32 v23, 4, v23
    s_mul_i32 s50, s3, 61440
    s_lshl_b32 s51, s49, 8
    s_add_u32 s50, s50, s51
    v_add3_u32 v6, v22, v23, s50
    v_add_u32 v7, 14336, v6
    v_add_u32 v8, 28672, v6
    v_add_u32 v9, 43008, v6
    s_lshl_b32 s56, s3, 12
    s_mov_b32 s38, 2621440
    s_mov_b32 s39, 0x00020000
    s_mov_b32 s42, 2457600
    s_mov_b32 s43, 0x00020000
    s_waitcnt lgkmcnt(0)
    s_mov_b64 s[36:37], s[8:9]
    s_mov_b64 s[40:41], s[10:11]
    s_add_u32 m0, s56, 0
    s_movk_i32 s54, 0
    buffer_load_dwordx4 v2, s[36:39], s54 offen offset:0 lds
    buffer_load_dwordx4 v3, s[36:39], s54 offen offset:1024 lds
    buffer_load_dwordx4 v4, s[36:39], s54 offen offset:2048 lds
    buffer_load_dwordx4 v5, s[36:39], s54 offen offset:3072 lds
    s_add_u32 m0, s56, 16384
    s_mov_b32 s55, 0
    buffer_load_dwordx4 v6, s[40:43], s55 offen offset:0 lds
    buffer_load_dwordx4 v7, s[40:43], s55 offen offset:1024 lds
    buffer_load_dwordx4 v8, s[40:43], s55 offen offset:2048 lds
    buffer_load_dwordx4 v9, s[40:43], s55 offen offset:3072 lds
    s_lshl2_add_u32 s50, s2, s3
    s_mul_i32 s51, s50, 6554
    s_lshr_b32 s51, s51, 16
    s_mul_i32 s52, s51, 10
    s_sub_u32 s50, s50, s52
    s_mul_i32 s68, s51, 10240
    s_lshl_b32 s52, s50, 7
    s_add_u32 s68, s68, s52
    v_lshrrev_b32 v22, 3, v1
    v_mul_u32_u24 v160, 1280, v22
    v_and_b32 v22, 7, v1
    v_lshl_add_u32 v160, v22, 4, v160
    s_mov_b32 s64, s14
    s_mov_b32 s65, s15
    s_mov_b32 s66, 2621440
    s_mov_b32 s67, 0x00020000
    s_cmp_lt_u32 s51, 64
    s_cselect_b32 s70, 0, 0x40000000
    s_cselect_b32 s62, 983040, 0
    s_lshl_b32 s69, s50, 18
    s_lshl_b32 s51, s51, 7
    s_add_u32 s69, s69, s51
    v_lshrrev_b32 v162, 3, v1
    v_lshlrev_b32 v162, 15, v162
    v_lshl_add_u32 v162, v22, 4, v162
    s_add_u32 s70, s70, 12288
    v_add_u32 v163, s70, v162
    v_bfe_u32 v22, v1, 2, 2
    v_lshrrev_b32 v23, 4, v1
    v_lshl_add_u32 v22, v22, 2, v23
    v_and_b32 v23, 3, v1
    v_lshl_add_u32 v22, v22, 2, v23
    s_add_u32 s51, s56, 131072
    v_lshl_add_u32 v161, v22, 3, s51
    s_add_u32 s72, s32, 14262272
    s_addc_u32 s73, s33, 0
    s_mov_b32 s74, 2621440
    s_mov_b32 s75, 0x00020000
    s_mov_b32 s44, s32
    s_mov_b32 s45, s33
    s_mov_b32 s46, 7864320
    s_mov_b32 s47, 0x00020000
    s_lshr_b32 s50, s3, 1
    s_and_b32 s51, s3, 1
    v_and_b32 v22, 31, v1
    v_lshrrev_b32 v23, 5, v1
    v_bfe_u32 v24, v1, 1, 3
    v_xor_b32 v24, v24, v23
    v_lshlrev_b32 v24, 4, v24
    v_lshl_add_u32 v24, v22, 7, v24
    s_lshl_b32 s52, s50, 13
    v_add_u32 v10, s52, v24
    v_xor_b32 v11, 32, v10
    v_xor_b32 v12, 64, v10
    v_xor_b32 v13, 96, v10
    v_bfe_u32 v24, v1, 2, 2
    v_lshl_add_u32 v25, v23, 3, v24
    v_lshlrev_b32 v25, 8, v25
    v_bfe_u32 v26, v1, 4, 1
    v_lshlrev_b32 v26, 5, v26
    v_and_b32 v27, 3, v1
    v_lshl_add_u32 v26, v27, 3, v26
    v_add_u32 v25, v25, v26
    v_add_u32 v25, 16384, v25
    s_lshl_b32 s52, s51, 1
    v_xor_b32 v26, s52, v24
    v_lshl_add_u32 v18, v26, 6, v25
    v_xor_b32 v19, 64, v18
    v_add_u32 v14, 65536, v10
    v_add_u32 v15, 65536, v11
    v_add_u32 v16, 65536, v12
    v_add_u32 v17, 65536, v13
    v_add_u32 v20, 65536, v18
    v_add_u32 v21, 65536, v19
    s_lshl_b32 s52, s48, 1
    s_add_u32 s52, s52, s50
    s_cmp_ge_u32 s49, 10
    s_cbranch_scc1 L_qkv_v_1
    s_cmp_ge_u32 s49, 5
    s_cselect_b32 s58, 1, 0
    s_cselect_b32 s59, 0, 5242880
    s_cselect_b32 s53, 5, 0
    s_lshl_b32 s57, 81920, s58
    s_lshl_b32 s58, 2560, s58
    s_sub_u32 s53, s49, s53
    s_mul_i32 s52, s52, s58
    s_add_u32 s59, s59, s52
    s_lshl1_add_u32 s53, s53, s51
    s_lshl_b32 s53, s53, 3
    s_mul_i32 s52, s53, 205
    s_lshr_b32 s52, s52, 10
    s_mul_i32 s60, s52, 5
    s_sub_u32 s60, s53, s60
    s_mul_i32 s52, s52, s57
    s_lshl1_add_u32 s8, s52, s59
    s_add_u32 s9, s8, s57
    s_add_u32 s10, s9, s57
    s_add_u32 s11, s10, s57
    s_add_u32 s12, s11, s57
    v_lshlrev_b32 v30, 9, v23
    v_lshl_add_u32 v30, v22, 4, v30
    v_mul_u32_u24 v31, s57, v23
    v_lshl_add_u32 v31, v22, 4, v31
    s_waitcnt vmcnt(0)
    s_add_u32 m0, s56, 32768
    s_movk_i32 s54, 128
    buffer_load_dwordx4 v2, s[36:39], s54 offen offset:0 lds
    buffer_load_dwordx4 v3, s[36:39], s54 offen offset:1024 lds
    buffer_load_dwordx4 v4, s[36:39], s54 offen offset:2048 lds
    buffer_load_dwordx4 v5, s[36:39], s54 offen offset:3072 lds
    s_add_u32 m0, s56, 49152
    s_mov_b32 s55, 245760
    buffer_load_dwordx4 v6, s[40:43], s55 offen offset:0 lds
    buffer_load_dwordx4 v7, s[40:43], s55 offen offset:1024 lds
    buffer_load_dwordx4 v8, s[40:43], s55 offen offset:2048 lds
    buffer_load_dwordx4 v9, s[40:43], s55 offen offset:3072 lds
    s_add_u32 m0, s56, 65536
    s_movk_i32 s54, 256
    buffer_load_dwordx4 v2, s[36:39], s54 offen offset:0 lds
    buffer_load_dwordx4 v3, s[36:39], s54 offen offset:1024 lds
    buffer_load_dwordx4 v4, s[36:39], s54 offen offset:2048 lds
    buffer_load_dwordx4 v5, s[36:39], s54 offen offset:3072 lds
    s_barrier
    s_add_u32 m0, s56, 81920
    s_mov_b32 s55, 491520
    buffer_load_dwordx4 v6, s[40:43], s55 offen offset:0 lds
    buffer_load_dwordx4 v7, s[40:43], s55 offen offset:1024 lds
    buffer_load_dwordx4 v8, s[40:43], s55 offen offset:2048 lds
    buffer_load_dwordx4 v9, s[40:43], s55 offen offset:3072 lds
    s_waitcnt vmcnt(16) lgkmcnt(0)
    s_barrier
    ds_read_b128 v[32:35], v10 offset:0
    ds_read_b64_tr_b16 v[40:41], v18 offset:0
    ds_read_b64_tr_b16 v[42:43], v18 offset:1024
    ds_read_b64_tr_b16 v[44:45], v19 offset:0
    ds_read_b64_tr_b16 v[46:47], v19 offset:1024
    ds_read_b128 v[36:39], v10 offset:4096
    ds_read_b128 v[48:51], v11 offset:0
    ds_read_b64_tr_b16 v[56:57], v18 offset:4096
    ds_read_b64_tr_b16 v[58:59], v18 offset:5120
    ds_read_b64_tr_b16 v[60:61], v19 offset:4096
    ds_read_b64_tr_b16 v[62:63], v19 offset:5120
    ds_read_b128 v[52:55], v11 offset:4096
    s_waitcnt lgkmcnt(6)
    v_mfma_f32_32x32x16_bf16 v[96:111], v[40:43], v[32:35], 0
    ds_read_b128 v[64:67], v12 offset:0
    ds_read_b64_tr_b16 v[72:73], v18 offset:8192
    s_add_u32 m0, s56, 98304
    s_movk_i32 s54, 384
    buffer_load_dwordx4 v2, s[36:39], s54 offen offset:0 lds
    v_mfma_f32_32x32x16_bf16 v[112:127], v[44:47], v[32:35], 0
    ds_read_b64_tr_b16 v[74:75], v18 offset:9216
    ds_read_b64_tr_b16 v[76:77], v19 offset:8192
    buffer_load_dwordx4 v3, s[36:39], s54 offen offset:1024 lds
    v_mfma_f32_32x32x16_bf16 v[128:143], v[40:43], v[36:39], 0
    ds_read_b64_tr_b16 v[78:79], v19 offset:9216
    ds_read_b128 v[68:71], v12 offset:4096
    buffer_load_dwordx4 v4, s[36:39], s54 offen offset:2048 lds
    v_mfma_f32_32x32x16_bf16 v[144:159], v[44:47], v[36:39], 0
    buffer_load_dwordx4 v5, s[36:39], s54 offen offset:3072 lds
    s_waitcnt lgkmcnt(6)
    v_mfma_f32_32x32x16_bf16 v[96:111], v[56:59], v[48:51], v[96:111]
    ds_read_b128 v[80:83], v13 offset:0
    ds_read_b64_tr_b16 v[88:89], v18 offset:12288
    ds_read_b64_tr_b16 v[90:91], v18 offset:13312
    s_add_u32 m0, s56, 114688
    s_mov_b32 s55, 737280
    buffer_load_dwordx4 v6, s[40:43], s55 offen offset:0 lds
    v_mfma_f32_32x32x16_bf16 v[112:127], v[60:63], v[48:51], v[112:127]
    ds_read_b64_tr_b16 v[92:93], v19 offset:12288
    ds_read_b64_tr_b16 v[94:95], v19 offset:13312
    ds_read_b128 v[84:87], v13 offset:4096
    buffer_load_dwordx4 v7, s[40:43], s55 offen offset:1024 lds
    v_mfma_f32_32x32x16_bf16 v[128:143], v[56:59], v[52:55], v[128:143]
    buffer_load_dwordx4 v8, s[40:43], s55 offen offset:2048 lds
    v_mfma_f32_32x32x16_bf16 v[144:159], v[60:63], v[52:55], v[144:159]
    buffer_load_dwordx4 v9, s[40:43], s55 offen offset:3072 lds
    s_waitcnt vmcnt(16) lgkmcnt(0)
    s_barrier
    v_mfma_f32_32x32x16_bf16 v[96:111], v[72:75], v[64:67], v[96:111]
    ds_read_b128 v[32:35], v10 offset:32768
    ds_read_b64_tr_b16 v[40:41], v18 offset:32768
    v_mfma_f32_32x32x16_bf16 v[112:127], v[76:79], v[64:67], v[112:127]
    ds_read_b64_tr_b16 v[42:43], v18 offset:33792
    ds_read_b64_tr_b16 v[44:45], v19 offset:32768
    s_add_u32 m0, s56, 0
    s_movk_i32 s54, 512
    buffer_load_dwordx4 v2, s[36:39], s54 offen offset:0 lds
    v_mfma_f32_32x32x16_bf16 v[128:143], v[72:75], v[68:71], v[128:143]
    ds_read_b64_tr_b16 v[46:47], v19 offset:33792
    ds_read_b128 v[36:39], v10 offset:36864
    v_mfma_f32_32x32x16_bf16 v[144:159], v[76:79], v[68:71], v[144:159]
    buffer_load_dwordx4 v3, s[36:39], s54 offen offset:1024 lds
    v_mfma_f32_32x32x16_bf16 v[96:111], v[88:91], v[80:83], v[96:111]
    ds_read_b128 v[48:51], v11 offset:32768
    ds_read_b64_tr_b16 v[56:57], v18 offset:36864
    v_mfma_f32_32x32x16_bf16 v[112:127], v[92:95], v[80:83], v[112:127]
    ds_read_b64_tr_b16 v[58:59], v18 offset:37888
    ds_read_b64_tr_b16 v[60:61], v19 offset:36864
    buffer_load_dwordx4 v4, s[36:39], s54 offen offset:2048 lds
    v_mfma_f32_32x32x16_bf16 v[128:143], v[88:91], v[84:87], v[128:143]
    ds_read_b64_tr_b16 v[62:63], v19 offset:37888
    ds_read_b128 v[52:55], v11 offset:36864
    v_mfma_f32_32x32x16_bf16 v[144:159], v[92:95], v[84:87], v[144:159]
    buffer_load_dwordx4 v5, s[36:39], s54 offen offset:3072 lds
    s_waitcnt lgkmcnt(6)
    v_mfma_f32_32x32x16_bf16 v[96:111], v[40:43], v[32:35], v[96:111]
    ds_read_b128 v[64:67], v12 offset:32768
    ds_read_b64_tr_b16 v[72:73], v18 offset:40960
    v_mfma_f32_32x32x16_bf16 v[112:127], v[44:47], v[32:35], v[112:127]
    ds_read_b64_tr_b16 v[74:75], v18 offset:41984
    ds_read_b64_tr_b16 v[76:77], v19 offset:40960
    s_add_u32 m0, s56, 16384
    s_mov_b32 s55, 983040
    buffer_load_dwordx4 v6, s[40:43], s55 offen offset:0 lds
    v_mfma_f32_32x32x16_bf16 v[128:143], v[40:43], v[36:39], v[128:143]
    ds_read_b64_tr_b16 v[78:79], v19 offset:41984
    ds_read_b128 v[68:71], v12 offset:36864
    v_mfma_f32_32x32x16_bf16 v[144:159], v[44:47], v[36:39], v[144:159]
    buffer_load_dwordx4 v7, s[40:43], s55 offen offset:1024 lds
    s_waitcnt lgkmcnt(6)
    v_mfma_f32_32x32x16_bf16 v[96:111], v[56:59], v[48:51], v[96:111]
    ds_read_b128 v[80:83], v13 offset:32768
    ds_read_b64_tr_b16 v[88:89], v18 offset:45056
    ds_read_b64_tr_b16 v[90:91], v18 offset:46080
    v_mfma_f32_32x32x16_bf16 v[112:127], v[60:63], v[48:51], v[112:127]
    ds_read_b64_tr_b16 v[92:93], v19 offset:45056
    ds_read_b64_tr_b16 v[94:95], v19 offset:46080
    ds_read_b128 v[84:87], v13 offset:36864
    buffer_load_dwordx4 v8, s[40:43], s55 offen offset:2048 lds
    v_mfma_f32_32x32x16_bf16 v[128:143], v[56:59], v[52:55], v[128:143]
    v_mfma_f32_32x32x16_bf16 v[144:159], v[60:63], v[52:55], v[144:159]
    buffer_load_dwordx4 v9, s[40:43], s55 offen offset:3072 lds
    s_waitcnt vmcnt(16) lgkmcnt(0)
    s_barrier
    v_mfma_f32_32x32x16_bf16 v[96:111], v[72:75], v[64:67], v[96:111]
    ds_read_b128 v[32:35], v14 offset:0
    ds_read_b64_tr_b16 v[40:41], v20 offset:0
    v_mfma_f32_32x32x16_bf16 v[112:127], v[76:79], v[64:67], v[112:127]
    ds_read_b64_tr_b16 v[42:43], v20 offset:1024
    ds_read_b64_tr_b16 v[44:45], v21 offset:0
    s_add_u32 m0, s56, 32768
    s_movk_i32 s54, 640
    buffer_load_dwordx4 v2, s[36:39], s54 offen offset:0 lds
    v_mfma_f32_32x32x16_bf16 v[128:143], v[72:75], v[68:71], v[128:143]
    ds_read_b64_tr_b16 v[46:47], v21 offset:1024
    ds_read_b128 v[36:39], v14 offset:4096
    v_mfma_f32_32x32x16_bf16 v[144:159], v[76:79], v[68:71], v[144:159]
    buffer_load_dwordx4 v3, s[36:39], s54 offen offset:1024 lds
    v_mfma_f32_32x32x16_bf16 v[96:111], v[88:91], v[80:83], v[96:111]
    ds_read_b128 v[48:51], v15 offset:0
    ds_read_b64_tr_b16 v[56:57], v20 offset:4096
    v_mfma_f32_32x32x16_bf16 v[112:127], v[92:95], v[80:83], v[112:127]
    ds_read_b64_tr_b16 v[58:59], v20 offset:5120
    ds_read_b64_tr_b16 v[60:61], v21 offset:4096
    buffer_load_dwordx4 v4, s[36:39], s54 offen offset:2048 lds
    v_mfma_f32_32x32x16_bf16 v[128:143], v[88:91], v[84:87], v[128:143]
    ds_read_b64_tr_b16 v[62:63], v21 offset:5120
    ds_read_b128 v[52:55], v15 offset:4096
    v_mfma_f32_32x32x16_bf16 v[144:159], v[92:95], v[84:87], v[144:159]
    buffer_load_dwordx4 v5, s[36:39], s54 offen offset:3072 lds
    s_waitcnt lgkmcnt(6)
    v_mfma_f32_32x32x16_bf16 v[96:111], v[40:43], v[32:35], v[96:111]
    ds_read_b128 v[64:67], v16 offset:0
    ds_read_b64_tr_b16 v[72:73], v20 offset:8192
    v_mfma_f32_32x32x16_bf16 v[112:127], v[44:47], v[32:35], v[112:127]
    ds_read_b64_tr_b16 v[74:75], v20 offset:9216
    ds_read_b64_tr_b16 v[76:77], v21 offset:8192
    s_add_u32 m0, s56, 49152
    s_mov_b32 s55, 1228800
    buffer_load_dwordx4 v6, s[40:43], s55 offen offset:0 lds
    v_mfma_f32_32x32x16_bf16 v[128:143], v[40:43], v[36:39], v[128:143]
    ds_read_b64_tr_b16 v[78:79], v21 offset:9216
    ds_read_b128 v[68:71], v16 offset:4096
    v_mfma_f32_32x32x16_bf16 v[144:159], v[44:47], v[36:39], v[144:159]
    buffer_load_dwordx4 v7, s[40:43], s55 offen offset:1024 lds
    s_waitcnt lgkmcnt(6)
    v_mfma_f32_32x32x16_bf16 v[96:111], v[56:59], v[48:51], v[96:111]
    ds_read_b128 v[80:83], v17 offset:0
    ds_read_b64_tr_b16 v[88:89], v20 offset:12288
    ds_read_b64_tr_b16 v[90:91], v20 offset:13312
    v_mfma_f32_32x32x16_bf16 v[112:127], v[60:63], v[48:51], v[112:127]
    ds_read_b64_tr_b16 v[92:93], v21 offset:12288
    ds_read_b64_tr_b16 v[94:95], v21 offset:13312
    ds_read_b128 v[84:87], v17 offset:4096
    buffer_load_dwordx4 v8, s[40:43], s55 offen offset:2048 lds
    v_mfma_f32_32x32x16_bf16 v[128:143], v[56:59], v[52:55], v[128:143]
    v_mfma_f32_32x32x16_bf16 v[144:159], v[60:63], v[52:55], v[144:159]
    buffer_load_dwordx4 v9, s[40:43], s55 offen offset:3072 lds
    s_waitcnt vmcnt(16) lgkmcnt(0)
    s_barrier
    v_mfma_f32_32x32x16_bf16 v[96:111], v[72:75], v[64:67], v[96:111]
    ds_read_b128 v[32:35], v14 offset:32768
    ds_read_b64_tr_b16 v[40:41], v20 offset:32768
    s_add_u32 m0, s56, 65536
    s_movk_i32 s54, 768
    buffer_load_dwordx4 v2, s[36:39], s54 offen offset:0 lds
    v_mfma_f32_32x32x16_bf16 v[112:127], v[76:79], v[64:67], v[112:127]
    ds_read_b64_tr_b16 v[42:43], v20 offset:33792
    ds_read_b64_tr_b16 v[44:45], v21 offset:32768
    v_mfma_f32_32x32x16_bf16 v[128:143], v[72:75], v[68:71], v[128:143]
    ds_read_b64_tr_b16 v[46:47], v21 offset:33792
    ds_read_b128 v[36:39], v14 offset:36864
    buffer_load_dwordx4 v3, s[36:39], s54 offen offset:1024 lds
    v_mfma_f32_32x32x16_bf16 v[144:159], v[76:79], v[68:71], v[144:159]
    buffer_load_dwordx4 v4, s[36:39], s54 offen offset:2048 lds
    v_mfma_f32_32x32x16_bf16 v[96:111], v[88:91], v[80:83], v[96:111]
    ds_read_b128 v[48:51], v15 offset:32768
    ds_read_b64_tr_b16 v[56:57], v20 offset:36864
    buffer_load_dwordx4 v5, s[36:39], s54 offen offset:3072 lds
    v_mfma_f32_32x32x16_bf16 v[112:127], v[92:95], v[80:83], v[112:127]
    ds_read_b64_tr_b16 v[58:59], v20 offset:37888
    ds_read_b64_tr_b16 v[60:61], v21 offset:36864
    v_mfma_f32_32x32x16_bf16 v[128:143], v[88:91], v[84:87], v[128:143]
    ds_read_b64_tr_b16 v[62:63], v21 offset:37888
    ds_read_b128 v[52:55], v15 offset:36864
    s_add_u32 m0, s56, 81920
    s_mov_b32 s55, 1474560
    buffer_load_dwordx4 v6, s[40:43], s55 offen offset:0 lds
    v_mfma_f32_32x32x16_bf16 v[144:159], v[92:95], v[84:87], v[144:159]
    buffer_load_dwordx4 v7, s[40:43], s55 offen offset:1024 lds
    s_waitcnt lgkmcnt(6)
    v_mfma_f32_32x32x16_bf16 v[96:111], v[40:43], v[32:35], v[96:111]
    ds_read_b128 v[64:67], v16 offset:32768
    ds_read_b64_tr_b16 v[72:73], v20 offset:40960
    buffer_load_dwordx4 v8, s[40:43], s55 offen offset:2048 lds
    v_mfma_f32_32x32x16_bf16 v[112:127], v[44:47], v[32:35], v[112:127]
    ds_read_b64_tr_b16 v[74:75], v20 offset:41984
    ds_read_b64_tr_b16 v[76:77], v21 offset:40960
    v_mfma_f32_32x32x16_bf16 v[128:143], v[40:43], v[36:39], v[128:143]
    ds_read_b64_tr_b16 v[78:79], v21 offset:41984
    ds_read_b128 v[68:71], v16 offset:36864
    buffer_load_dwordx4 v9, s[40:43], s55 offen offset:3072 lds
    v_mfma_f32_32x32x16_bf16 v[144:159], v[44:47], v[36:39], v[144:159]
    s_add_u32 m0, s56, 131072
    s_nop 0
    buffer_load_dwordx4 v160, s[64:67], s68 offen nt lds
    s_waitcnt lgkmcnt(6)
    v_mfma_f32_32x32x16_bf16 v[96:111], v[56:59], v[48:51], v[96:111]
    ds_read_b128 v[80:83], v17 offset:32768
    ds_read_b64_tr_b16 v[88:89], v20 offset:45056
    ds_read_b64_tr_b16 v[90:91], v20 offset:46080
    s_add_u32 m0, s56, 132096
    s_add_u32 s68, s68, 983040
    buffer_load_dwordx4 v160, s[64:67], s68 offen nt lds
    v_mfma_f32_32x32x16_bf16 v[112:127], v[60:63], v[48:51], v[112:127]
    ds_read_b64_tr_b16 v[92:93], v21 offset:45056
    ds_read_b64_tr_b16 v[94:95], v21 offset:46080
    ds_read_b128 v[84:87], v17 offset:36864
    v_mfma_f32_32x32x16_bf16 v[128:143], v[56:59], v[52:55], v[128:143]
    s_add_u32 m0, s56, 133120
    s_add_u32 s68, s68, s62
    buffer_load_dwordx4 v160, s[64:67], s68 offen nt lds
    v_mfma_f32_32x32x16_bf16 v[144:159], v[60:63], v[52:55], v[144:159]
    s_waitcnt vmcnt(19) lgkmcnt(0)
    s_barrier
    v_mfma_f32_32x32x16_bf16 v[96:111], v[72:75], v[64:67], v[96:111]
    ds_read_b128 v[32:35], v10 offset:0
    ds_read_b64_tr_b16 v[40:41], v18 offset:0
    v_mfma_f32_32x32x16_bf16 v[112:127], v[76:79], v[64:67], v[112:127]
    ds_read_b64_tr_b16 v[42:43], v18 offset:1024
    ds_read_b64_tr_b16 v[44:45], v19 offset:0
    s_add_u32 m0, s56, 98304
    s_movk_i32 s54, 896
    buffer_load_dwordx4 v2, s[36:39], s54 offen offset:0 lds
    v_mfma_f32_32x32x16_bf16 v[128:143], v[72:75], v[68:71], v[128:143]
    ds_read_b64_tr_b16 v[46:47], v19 offset:1024
    ds_read_b128 v[36:39], v10 offset:4096
    v_mfma_f32_32x32x16_bf16 v[144:159], v[76:79], v[68:71], v[144:159]
    buffer_load_dwordx4 v3, s[36:39], s54 offen offset:1024 lds
    v_mfma_f32_32x32x16_bf16 v[96:111], v[88:91], v[80:83], v[96:111]
    ds_read_b128 v[48:51], v11 offset:0
    ds_read_b64_tr_b16 v[56:57], v18 offset:4096
    v_mfma_f32_32x32x16_bf16 v[112:127], v[92:95], v[80:83], v[112:127]
    ds_read_b64_tr_b16 v[58:59], v18 offset:5120
    ds_read_b64_tr_b16 v[60:61], v19 offset:4096
    buffer_load_dwordx4 v4, s[36:39], s54 offen offset:2048 lds
    v_mfma_f32_32x32x16_bf16 v[128:143], v[88:91], v[84:87], v[128:143]
    ds_read_b64_tr_b16 v[62:63], v19 offset:5120
    ds_read_b128 v[52:55], v11 offset:4096
    v_mfma_f32_32x32x16_bf16 v[144:159], v[92:95], v[84:87], v[144:159]
    buffer_load_dwordx4 v5, s[36:39], s54 offen offset:3072 lds
    s_waitcnt lgkmcnt(6)
    v_mfma_f32_32x32x16_bf16 v[96:111], v[40:43], v[32:35], v[96:111]
    ds_read_b128 v[64:67], v12 offset:0
    ds_read_b64_tr_b16 v[72:73], v18 offset:8192
    v_mfma_f32_32x32x16_bf16 v[112:127], v[44:47], v[32:35], v[112:127]
    ds_read_b64_tr_b16 v[74:75], v18 offset:9216
    ds_read_b64_tr_b16 v[76:77], v19 offset:8192
    s_add_u32 m0, s56, 114688
    s_mov_b32 s55, 1720320
    buffer_load_dwordx4 v6, s[40:43], s55 offen offset:0 lds
    v_mfma_f32_32x32x16_bf16 v[128:143], v[40:43], v[36:39], v[128:143]
    ds_read_b64_tr_b16 v[78:79], v19 offset:9216
    ds_read_b128 v[68:71], v12 offset:4096
    v_mfma_f32_32x32x16_bf16 v[144:159], v[44:47], v[36:39], v[144:159]
    buffer_load_dwordx4 v7, s[40:43], s55 offen offset:1024 lds
    s_waitcnt lgkmcnt(6)
    v_mfma_f32_32x32x16_bf16 v[96:111], v[56:59], v[48:51], v[96:111]
    ds_read_b128 v[80:83], v13 offset:0
    ds_read_b64_tr_b16 v[88:89], v18 offset:12288
    ds_read_b64_tr_b16 v[90:91], v18 offset:13312
    v_mfma_f32_32x32x16_bf16 v[112:127], v[60:63], v[48:51], v[112:127]
    ds_read_b64_tr_b16 v[92:93], v19 offset:12288
    ds_read_b64_tr_b16 v[94:95], v19 offset:13312
    ds_read_b128 v[84:87], v13 offset:4096
    buffer_load_dwordx4 v8, s[40:43], s55 offen offset:2048 lds
    v_mfma_f32_32x32x16_bf16 v[128:143], v[56:59], v[52:55], v[128:143]
    v_mfma_f32_32x32x16_bf16 v[144:159], v[60:63], v[52:55], v[144:159]
    buffer_load_dwordx4 v9, s[40:43], s55 offen offset:3072 lds
    s_waitcnt vmcnt(19) lgkmcnt(0)
    s_barrier
    v_mfma_f32_32x32x16_bf16 v[96:111], v[72:75], v[64:67], v[96:111]
    ds_read_b128 v[32:35], v10 offset:32768
    ds_read_b64_tr_b16 v[40:41], v18 offset:32768
    v_mfma_f32_32x32x16_bf16 v[112:127], v[76:79], v[64:67], v[112:127]
    ds_read_b64_tr_b16 v[42:43], v18 offset:33792
    ds_read_b64_tr_b16 v[44:45], v19 offset:32768
    s_add_u32 m0, s56, 0
    s_movk_i32 s54, 1024
    buffer_load_dwordx4 v2, s[36:39], s54 offen offset:0 lds
    v_mfma_f32_32x32x16_bf16 v[128:143], v[72:75], v[68:71], v[128:143]
    ds_read_b64_tr_b16 v[46:47], v19 offset:33792
    ds_read_b128 v[36:39], v10 offset:36864
    v_mfma_f32_32x32x16_bf16 v[144:159], v[76:79], v[68:71], v[144:159]
    buffer_load_dwordx4 v3, s[36:39], s54 offen offset:1024 lds
    v_mfma_f32_32x32x16_bf16 v[96:111], v[88:91], v[80:83], v[96:111]
    ds_read_b128 v[48:51], v11 offset:32768
    ds_read_b64_tr_b16 v[56:57], v18 offset:36864
    v_mfma_f32_32x32x16_bf16 v[112:127], v[92:95], v[80:83], v[112:127]
    ds_read_b64_tr_b16 v[58:59], v18 offset:37888
    ds_read_b64_tr_b16 v[60:61], v19 offset:36864
    buffer_load_dwordx4 v4, s[36:39], s54 offen offset:2048 lds
    v_mfma_f32_32x32x16_bf16 v[128:143], v[88:91], v[84:87], v[128:143]
    ds_read_b64_tr_b16 v[62:63], v19 offset:37888
    ds_read_b128 v[52:55], v11 offset:36864
    v_mfma_f32_32x32x16_bf16 v[144:159], v[92:95], v[84:87], v[144:159]
    buffer_load_dwordx4 v5, s[36:39], s54 offen offset:3072 lds
    s_waitcnt lgkmcnt(6)
    v_mfma_f32_32x32x16_bf16 v[96:111], v[40:43], v[32:35], v[96:111]
    ds_read_b128 v[64:67], v12 offset:32768
    ds_read_b64_tr_b16 v[72:73], v18 offset:40960
    v_mfma_f32_32x32x16_bf16 v[112:127], v[44:47], v[32:35], v[112:127]
    ds_read_b64_tr_b16 v[74:75], v18 offset:41984
    ds_read_b64_tr_b16 v[76:77], v19 offset:40960
    s_add_u32 m0, s56, 16384
    s_mov_b32 s55, 1966080
    buffer_load_dwordx4 v6, s[40:43], s55 offen offset:0 lds
    v_mfma_f32_32x32x16_bf16 v[128:143], v[40:43], v[36:39], v[128:143]
    ds_read_b64_tr_b16 v[78:79], v19 offset:41984
    ds_read_b128 v[68:71], v12 offset:36864
    v_mfma_f32_32x32x16_bf16 v[144:159], v[44:47], v[36:39], v[144:159]
    buffer_load_dwordx4 v7, s[40:43], s55 offen offset:1024 lds
    s_waitcnt lgkmcnt(6)
    v_mfma_f32_32x32x16_bf16 v[96:111], v[56:59], v[48:51], v[96:111]
    ds_read_b128 v[80:83], v13 offset:32768
    ds_read_b64_tr_b16 v[88:89], v18 offset:45056
    ds_read_b64_tr_b16 v[90:91], v18 offset:46080
    v_mfma_f32_32x32x16_bf16 v[112:127], v[60:63], v[48:51], v[112:127]
    ds_read_b64_tr_b16 v[92:93], v19 offset:45056
    ds_read_b64_tr_b16 v[94:95], v19 offset:46080
    ds_read_b128 v[84:87], v13 offset:36864
    buffer_load_dwordx4 v8, s[40:43], s55 offen offset:2048 lds
    v_mfma_f32_32x32x16_bf16 v[128:143], v[56:59], v[52:55], v[128:143]
    v_mfma_f32_32x32x16_bf16 v[144:159], v[60:63], v[52:55], v[144:159]
    buffer_load_dwordx4 v9, s[40:43], s55 offen offset:3072 lds
    s_waitcnt vmcnt(19) lgkmcnt(0)
    s_barrier
    v_mfma_f32_32x32x16_bf16 v[96:111], v[72:75], v[64:67], v[96:111]
    ds_read_b128 v[32:35], v14 offset:0
    ds_read_b64_tr_b16 v[40:41], v20 offset:0
    v_mfma_f32_32x32x16_bf16 v[112:127], v[76:79], v[64:67], v[112:127]
    ds_read_b64_tr_b16 v[42:43], v20 offset:1024
    ds_read_b64_tr_b16 v[44:45], v21 offset:0
    s_add_u32 m0, s56, 32768
    s_movk_i32 s54, 1152
    buffer_load_dwordx4 v2, s[36:39], s54 offen offset:0 lds
    v_mfma_f32_32x32x16_bf16 v[128:143], v[72:75], v[68:71], v[128:143]
    ds_read_b64_tr_b16 v[46:47], v21 offset:1024
    ds_read_b128 v[36:39], v14 offset:4096
    v_mfma_f32_32x32x16_bf16 v[144:159], v[76:79], v[68:71], v[144:159]
    buffer_load_dwordx4 v3, s[36:39], s54 offen offset:1024 lds
    v_mfma_f32_32x32x16_bf16 v[96:111], v[88:91], v[80:83], v[96:111]
    ds_read_b128 v[48:51], v15 offset:0
    ds_read_b64_tr_b16 v[56:57], v20 offset:4096
    v_mfma_f32_32x32x16_bf16 v[112:127], v[92:95], v[80:83], v[112:127]
    ds_read_b64_tr_b16 v[58:59], v20 offset:5120
    ds_read_b64_tr_b16 v[60:61], v21 offset:4096
    buffer_load_dwordx4 v4, s[36:39], s54 offen offset:2048 lds
    v_mfma_f32_32x32x16_bf16 v[128:143], v[88:91], v[84:87], v[128:143]
    ds_read_b64_tr_b16 v[62:63], v21 offset:5120
    ds_read_b128 v[52:55], v15 offset:4096
    v_mfma_f32_32x32x16_bf16 v[144:159], v[92:95], v[84:87], v[144:159]
    buffer_load_dwordx4 v5, s[36:39], s54 offen offset:3072 lds
    s_waitcnt lgkmcnt(6)
    v_mfma_f32_32x32x16_bf16 v[96:111], v[40:43], v[32:35], v[96:111]
    ds_read_b128 v[64:67], v16 offset:0
    ds_read_b64_tr_b16 v[72:73], v20 offset:8192
    v_mfma_f32_32x32x16_bf16 v[112:127], v[44:47], v[32:35], v[112:127]
    ds_read_b64_tr_b16 v[74:75], v20 offset:9216
    ds_read_b64_tr_b16 v[76:77], v21 offset:8192
    s_add_u32 m0, s56, 49152
    s_mov_b32 s55, 2211840
    buffer_load_dwordx4 v6, s[40:43], s55 offen offset:0 lds
    v_mfma_f32_32x32x16_bf16 v[128:143], v[40:43], v[36:39], v[128:143]
    ds_read_b64_tr_b16 v[78:79], v21 offset:9216
    ds_read_b128 v[68:71], v16 offset:4096
    v_mfma_f32_32x32x16_bf16 v[144:159], v[44:47], v[36:39], v[144:159]
    buffer_load_dwordx4 v7, s[40:43], s55 offen offset:1024 lds
    s_waitcnt lgkmcnt(6)
    v_mfma_f32_32x32x16_bf16 v[96:111], v[56:59], v[48:51], v[96:111]
    ds_read_b128 v[80:83], v17 offset:0
    ds_read_b64_tr_b16 v[88:89], v20 offset:12288
    ds_read_b64_tr_b16 v[90:91], v20 offset:13312
    v_mfma_f32_32x32x16_bf16 v[112:127], v[60:63], v[48:51], v[112:127]
    ds_read_b64_tr_b16 v[92:93], v21 offset:12288
    ds_read_b64_tr_b16 v[94:95], v21 offset:13312
    ds_read_b128 v[84:87], v17 offset:4096
    buffer_load_dwordx4 v8, s[40:43], s55 offen offset:2048 lds
    v_mfma_f32_32x32x16_bf16 v[128:143], v[56:59], v[52:55], v[128:143]
    v_mfma_f32_32x32x16_bf16 v[144:159], v[60:63], v[52:55], v[144:159]
    buffer_load_dwordx4 v9, s[40:43], s55 offen offset:3072 lds
    s_waitcnt vmcnt(16) lgkmcnt(0)
    s_barrier
    ds_read_b64_tr_b16 v[164:165], v161 offset:0
    ds_read_b64_tr_b16 v[166:167], v161 offset:512
    ds_read_b64_tr_b16 v[168:169], v161 offset:1024
    ds_read_b64_tr_b16 v[170:171], v161 offset:1536
    ds_read_b64_tr_b16 v[172:173], v161 offset:2048
    ds_read_b64_tr_b16 v[174:175], v161 offset:2560
    v_mfma_f32_32x32x16_bf16 v[96:111], v[72:75], v[64:67], v[96:111]
    ds_read_b128 v[32:35], v14 offset:32768
    ds_read_b64_tr_b16 v[40:41], v20 offset:32768
    v_mfma_f32_32x32x16_bf16 v[112:127], v[76:79], v[64:67], v[112:127]
    ds_read_b64_tr_b16 v[42:43], v20 offset:33792
    ds_read_b64_tr_b16 v[44:45], v21 offset:32768
    v_mfma_f32_32x32x16_bf16 v[128:143], v[72:75], v[68:71], v[128:143]
    ds_read_b64_tr_b16 v[46:47], v21 offset:33792
    ds_read_b128 v[36:39], v14 offset:36864
    v_mfma_f32_32x32x16_bf16 v[144:159], v[76:79], v[68:71], v[144:159]
    v_mfma_f32_32x32x16_bf16 v[96:111], v[88:91], v[80:83], v[96:111]
    ds_read_b128 v[48:51], v15 offset:32768
    ds_read_b64_tr_b16 v[56:57], v20 offset:36864
    v_mfma_f32_32x32x16_bf16 v[112:127], v[92:95], v[80:83], v[112:127]
    ds_read_b64_tr_b16 v[58:59], v20 offset:37888
    ds_read_b64_tr_b16 v[60:61], v21 offset:36864
    v_mfma_f32_32x32x16_bf16 v[128:143], v[88:91], v[84:87], v[128:143]
    ds_read_b64_tr_b16 v[62:63], v21 offset:37888
    ds_read_b128 v[52:55], v15 offset:36864
    v_mfma_f32_32x32x16_bf16 v[144:159], v[92:95], v[84:87], v[144:159]
    s_waitcnt lgkmcnt(6)
    v_mfma_f32_32x32x16_bf16 v[96:111], v[40:43], v[32:35], v[96:111]
    ds_read_b128 v[64:67], v16 offset:32768
    ds_read_b64_tr_b16 v[72:73], v20 offset:40960
    buffer_store_dwordx4 v[164:167], v162, s[72:75], s69 offen sc1
    s_add_u32 s69, s69, 12288
    v_mfma_f32_32x32x16_bf16 v[112:127], v[44:47], v[32:35], v[112:127]
    ds_read_b64_tr_b16 v[74:75], v20 offset:41984
    ds_read_b64_tr_b16 v[76:77], v21 offset:40960
    v_mfma_f32_32x32x16_bf16 v[128:143], v[40:43], v[36:39], v[128:143]
    ds_read_b64_tr_b16 v[78:79], v21 offset:41984
    ds_read_b128 v[68:71], v16 offset:36864
    buffer_store_dwordx4 v[168:171], v162, s[72:75], s69 offen sc1
    v_mfma_f32_32x32x16_bf16 v[144:159], v[44:47], v[36:39], v[144:159]
    s_waitcnt lgkmcnt(6)
    v_mfma_f32_32x32x16_bf16 v[96:111], v[56:59], v[48:51], v[96:111]
    ds_read_b128 v[80:83], v17 offset:32768
    ds_read_b64_tr_b16 v[88:89], v20 offset:45056
    ds_read_b64_tr_b16 v[90:91], v20 offset:46080
    buffer_store_dwordx4 v[172:175], v163, s[72:75], s69 offen sc1
    v_mfma_f32_32x32x16_bf16 v[112:127], v[60:63], v[48:51], v[112:127]
    ds_read_b64_tr_b16 v[92:93], v21 offset:45056
    ds_read_b64_tr_b16 v[94:95], v21 offset:46080
    ds_read_b128 v[84:87], v17 offset:36864
    v_mfma_f32_32x32x16_bf16 v[128:143], v[56:59], v[52:55], v[128:143]
    v_mfma_f32_32x32x16_bf16 v[144:159], v[60:63], v[52:55], v[144:159]
    s_waitcnt vmcnt(11) lgkmcnt(0)
    s_barrier
    v_mfma_f32_32x32x16_bf16 v[96:111], v[72:75], v[64:67], v[96:111]
    ds_read_b128 v[32:35], v10 offset:0
    ds_read_b64_tr_b16 v[40:41], v18 offset:0
    v_mfma_f32_32x32x16_bf16 v[112:127], v[76:79], v[64:67], v[112:127]
    ds_read_b64_tr_b16 v[42:43], v18 offset:1024
    ds_read_b64_tr_b16 v[44:45], v19 offset:0
    v_mfma_f32_32x32x16_bf16 v[128:143], v[72:75], v[68:71], v[128:143]
    ds_read_b64_tr_b16 v[46:47], v19 offset:1024
    ds_read_b128 v[36:39], v10 offset:4096
    v_mfma_f32_32x32x16_bf16 v[144:159], v[76:79], v[68:71], v[144:159]
    v_mfma_f32_32x32x16_bf16 v[96:111], v[88:91], v[80:83], v[96:111]
    ds_read_b128 v[48:51], v11 offset:0
    ds_read_b64_tr_b16 v[56:57], v18 offset:4096
    v_mfma_f32_32x32x16_bf16 v[112:127], v[92:95], v[80:83], v[112:127]
    ds_read_b64_tr_b16 v[58:59], v18 offset:5120
    ds_read_b64_tr_b16 v[60:61], v19 offset:4096
    v_mfma_f32_32x32x16_bf16 v[128:143], v[88:91], v[84:87], v[128:143]
    ds_read_b64_tr_b16 v[62:63], v19 offset:5120
    ds_read_b128 v[52:55], v11 offset:4096
    v_mfma_f32_32x32x16_bf16 v[144:159], v[92:95], v[84:87], v[144:159]
    s_waitcnt lgkmcnt(6)
    v_mfma_f32_32x32x16_bf16 v[96:111], v[40:43], v[32:35], v[96:111]
    ds_read_b128 v[64:67], v12 offset:0
    ds_read_b64_tr_b16 v[72:73], v18 offset:8192
    v_mfma_f32_32x32x16_bf16 v[112:127], v[44:47], v[32:35], v[112:127]
    ds_read_b64_tr_b16 v[74:75], v18 offset:9216
    ds_read_b64_tr_b16 v[76:77], v19 offset:8192
    v_mfma_f32_32x32x16_bf16 v[128:143], v[40:43], v[36:39], v[128:143]
    ds_read_b64_tr_b16 v[78:79], v19 offset:9216
    ds_read_b128 v[68:71], v12 offset:4096
    v_mfma_f32_32x32x16_bf16 v[144:159], v[44:47], v[36:39], v[144:159]
    s_waitcnt lgkmcnt(6)
    v_mfma_f32_32x32x16_bf16 v[96:111], v[56:59], v[48:51], v[96:111]
    ds_read_b128 v[80:83], v13 offset:0
    ds_read_b64_tr_b16 v[88:89], v18 offset:12288
    ds_read_b64_tr_b16 v[90:91], v18 offset:13312
    v_mfma_f32_32x32x16_bf16 v[112:127], v[60:63], v[48:51], v[112:127]
    ds_read_b64_tr_b16 v[92:93], v19 offset:12288
    ds_read_b64_tr_b16 v[94:95], v19 offset:13312
    ds_read_b128 v[84:87], v13 offset:4096
    v_mfma_f32_32x32x16_bf16 v[128:143], v[56:59], v[52:55], v[128:143]
    v_mfma_f32_32x32x16_bf16 v[144:159], v[60:63], v[52:55], v[144:159]
    s_waitcnt vmcnt(3) lgkmcnt(0)
    s_barrier
    v_mfma_f32_32x32x16_bf16 v[96:111], v[72:75], v[64:67], v[96:111]
    ds_read_b128 v[32:35], v10 offset:32768
    ds_read_b64_tr_b16 v[40:41], v18 offset:32768
    v_mfma_f32_32x32x16_bf16 v[112:127], v[76:79], v[64:67], v[112:127]
    ds_read_b64_tr_b16 v[42:43], v18 offset:33792
    ds_read_b64_tr_b16 v[44:45], v19 offset:32768
    v_mfma_f32_32x32x16_bf16 v[128:143], v[72:75], v[68:71], v[128:143]
    ds_read_b64_tr_b16 v[46:47], v19 offset:33792
    ds_read_b128 v[36:39], v10 offset:36864
    v_mfma_f32_32x32x16_bf16 v[144:159], v[76:79], v[68:71], v[144:159]
    v_mfma_f32_32x32x16_bf16 v[96:111], v[88:91], v[80:83], v[96:111]
    ds_read_b128 v[48:51], v11 offset:32768
    ds_read_b64_tr_b16 v[56:57], v18 offset:36864
    ds_read_b64_tr_b16 v[58:59], v18 offset:37888
    v_mfma_f32_32x32x16_bf16 v[112:127], v[92:95], v[80:83], v[112:127]
    ds_read_b64_tr_b16 v[60:61], v19 offset:36864
    ds_read_b64_tr_b16 v[62:63], v19 offset:37888
    ds_read_b128 v[52:55], v11 offset:36864
    v_mfma_f32_32x32x16_bf16 v[128:143], v[88:91], v[84:87], v[128:143]
    ds_read_b128 v[64:67], v12 offset:32768
    ds_read_b64_tr_b16 v[72:73], v18 offset:40960
    ds_read_b64_tr_b16 v[74:75], v18 offset:41984
    v_mfma_f32_32x32x16_bf16 v[144:159], v[92:95], v[84:87], v[144:159]
    ds_read_b64_tr_b16 v[76:77], v19 offset:40960
    ds_read_b64_tr_b16 v[78:79], v19 offset:41984
    ds_read_b128 v[68:71], v12 offset:36864
    s_waitcnt lgkmcnt(12)
    v_mfma_f32_32x32x16_bf16 v[96:111], v[40:43], v[32:35], v[96:111]
    ds_read_b128 v[80:83], v13 offset:32768
    ds_read_b64_tr_b16 v[88:89], v18 offset:45056
    ds_read_b64_tr_b16 v[90:91], v18 offset:46080
    v_mfma_f32_32x32x16_bf16 v[112:127], v[44:47], v[32:35], v[112:127]
    ds_read_b64_tr_b16 v[92:93], v19 offset:45056
    ds_read_b64_tr_b16 v[94:95], v19 offset:46080
    ds_read_b128 v[84:87], v13 offset:36864
    s_waitcnt lgkmcnt(12)
    v_mfma_f32_32x32x16_bf16 v[96:111], v[56:59], v[48:51], v[96:111]
    v_mfma_f32_32x32x16_bf16 v[112:127], v[60:63], v[48:51], v[112:127]
    s_waitcnt lgkmcnt(6)
    v_mfma_f32_32x32x16_bf16 v[96:111], v[72:75], v[64:67], v[96:111]
    v_mfma_f32_32x32x16_bf16 v[112:127], v[76:79], v[64:67], v[112:127]
    s_waitcnt lgkmcnt(1)
    v_mfma_f32_32x32x16_bf16 v[96:111], v[88:91], v[80:83], v[96:111]
    v_mfma_f32_32x32x16_bf16 v[112:127], v[92:95], v[80:83], v[112:127]
    s_cmp_eq_u32 s60, 1
    s_cbranch_scc1 L_qkv_ph_3
    s_cmp_eq_u32 s60, 2
    s_cbranch_scc1 L_qkv_ph_4
    s_cmp_eq_u32 s60, 3
    s_cbranch_scc1 L_qkv_ph_5
    s_cmp_eq_u32 s60, 4
    s_cbranch_scc1 L_qkv_ph_6
L_qkv_ph_2:
    s_waitcnt lgkmcnt(0)
    v_mfma_f32_32x32x16_bf16 v[128:143], v[40:43], v[36:39], v[128:143]
    v_mfma_f32_32x32x16_bf16 v[144:159], v[44:47], v[36:39], v[144:159]
    v_cvt_pk_bf16_f32 v96, v96, v97
    v_cvt_pk_bf16_f32 v97, v98, v99
    v_cvt_pk_bf16_f32 v98, v100, v101
    v_mfma_f32_32x32x16_bf16 v[128:143], v[56:59], v[52:55], v[128:143]
    v_cvt_pk_bf16_f32 v99, v102, v103
    buffer_store_dwordx4 v[96:99], v30, s[44:47], s8 offen offset:0 sc1
    v_cvt_pk_bf16_f32 v164, v104, v105
    v_mfma_f32_32x32x16_bf16 v[144:159], v[60:63], v[52:55], v[144:159]
    v_cvt_pk_bf16_f32 v165, v106, v107
    v_cvt_pk_bf16_f32 v102, v108, v109
    v_cvt_pk_bf16_f32 v103, v110, v111
    v_mfma_f32_32x32x16_bf16 v[128:143], v[72:75], v[68:71], v[128:143]
    v_cvt_pk_bf16_f32 v104, v112, v113
    v_cvt_pk_bf16_f32 v105, v114, v115
    buffer_store_dwordx4 v[102:105], v30, s[44:47], s9 offen offset:0 sc1
    v_mfma_f32_32x32x16_bf16 v[144:159], v[76:79], v[68:71], v[144:159]
    v_cvt_pk_bf16_f32 v106, v116, v117
    v_cvt_pk_bf16_f32 v107, v118, v119
    v_cvt_pk_bf16_f32 v108, v120, v121
    v_mfma_f32_32x32x16_bf16 v[128:143], v[88:91], v[84:87], v[128:143]
    v_cvt_pk_bf16_f32 v109, v122, v123
    buffer_store_dwordx4 v[106:109], v30, s[44:47], s10 offen offset:0 sc1
    v_mfma_f32_32x32x16_bf16 v[144:159], v[92:95], v[84:87], v[144:159]
    v_cvt_pk_bf16_f32 v168, v124, v125
    v_cvt_pk_bf16_f32 v169, v126, v127
    s_nop 7
    v_cvt_pk_bf16_f32 v128, v128, v129
    v_cvt_pk_bf16_f32 v129, v130, v131
    v_cvt_pk_bf16_f32 v130, v132, v133
    v_cvt_pk_bf16_f32 v131, v134, v135
    buffer_store_dwordx4 v[128:131], v30, s[44:47], s8 offen offset:1024 sc1
    v_cvt_pk_bf16_f32 v166, v136, v137
    v_cvt_pk_bf16_f32 v167, v138, v139
    buffer_store_dwordx4 v[164:167], v31, s[44:47], s8 offen offset:2048 sc1
    v_cvt_pk_bf16_f32 v134, v140, v141
    v_cvt_pk_bf16_f32 v135, v142, v143
    v_cvt_pk_bf16_f32 v136, v144, v145
    v_cvt_pk_bf16_f32 v137, v146, v147
    buffer_store_dwordx4 v[134:137], v30, s[44:47], s9 offen offset:1024 sc1
    v_cvt_pk_bf16_f32 v138, v148, v149
    v_cvt_pk_bf16_f32 v139, v150, v151
    v_cvt_pk_bf16_f32 v140, v152, v153
    v_cvt_pk_bf16_f32 v141, v154, v155
    buffer_store_dwordx4 v[138:141], v30, s[44:47], s10 offen offset:1024 sc1
    v_cvt_pk_bf16_f32 v170, v156, v157
    v_cvt_pk_bf16_f32 v171, v158, v159
    buffer_store_dwordx4 v[168:171], v31, s[44:47], s10 offen offset:2048 sc1
    s_branch L_qkv_kernel_done
L_qkv_ph_3:
    s_waitcnt lgkmcnt(0)
    v_mfma_f32_32x32x16_bf16 v[128:143], v[40:43], v[36:39], v[128:143]
    v_mfma_f32_32x32x16_bf16 v[144:159], v[44:47], v[36:39], v[144:159]
    v_cvt_pk_bf16_f32 v96, v96, v97
    v_cvt_pk_bf16_f32 v97, v98, v99
    buffer_store_dwordx2 v[96:97], v30, s[44:47], s8 offen offset:8
    v_mfma_f32_32x32x16_bf16 v[128:143], v[56:59], v[52:55], v[128:143]
    v_cvt_pk_bf16_f32 v164, v100, v101
    v_cvt_pk_bf16_f32 v165, v102, v103
    v_cvt_pk_bf16_f32 v100, v104, v105
    v_mfma_f32_32x32x16_bf16 v[144:159], v[60:63], v[52:55], v[144:159]
    v_cvt_pk_bf16_f32 v101, v106, v107
    v_cvt_pk_bf16_f32 v102, v108, v109
    v_cvt_pk_bf16_f32 v103, v110, v111
    v_mfma_f32_32x32x16_bf16 v[128:143], v[72:75], v[68:71], v[128:143]
    buffer_store_dwordx4 v[100:103], v30, s[44:47], s9 offen offset:0 sc1
    v_cvt_pk_bf16_f32 v104, v112, v113
    v_cvt_pk_bf16_f32 v105, v114, v115
    v_mfma_f32_32x32x16_bf16 v[144:159], v[76:79], v[68:71], v[144:159]
    v_cvt_pk_bf16_f32 v106, v116, v117
    v_cvt_pk_bf16_f32 v107, v118, v119
    buffer_store_dwordx4 v[104:107], v30, s[44:47], s10 offen offset:0 sc1
    v_mfma_f32_32x32x16_bf16 v[128:143], v[88:91], v[84:87], v[128:143]
    v_cvt_pk_bf16_f32 v168, v120, v121
    v_cvt_pk_bf16_f32 v169, v122, v123
    v_cvt_pk_bf16_f32 v110, v124, v125
    v_mfma_f32_32x32x16_bf16 v[144:159], v[92:95], v[84:87], v[144:159]
    v_cvt_pk_bf16_f32 v111, v126, v127
    buffer_store_dwordx2 v[110:111], v30, s[44:47], s11 offen offset:0
    s_nop 7
    v_cvt_pk_bf16_f32 v128, v128, v129
    v_cvt_pk_bf16_f32 v129, v130, v131
    buffer_store_dwordx2 v[128:129], v30, s[44:47], s8 offen offset:1032
    v_cvt_pk_bf16_f32 v166, v132, v133
    v_cvt_pk_bf16_f32 v167, v134, v135
    buffer_store_dwordx4 v[164:167], v31, s[44:47], s8 offen offset:2048 sc1
    v_cvt_pk_bf16_f32 v132, v136, v137
    v_cvt_pk_bf16_f32 v133, v138, v139
    v_cvt_pk_bf16_f32 v134, v140, v141
    v_cvt_pk_bf16_f32 v135, v142, v143
    buffer_store_dwordx4 v[132:135], v30, s[44:47], s9 offen offset:1024 sc1
    v_cvt_pk_bf16_f32 v136, v144, v145
    v_cvt_pk_bf16_f32 v137, v146, v147
    v_cvt_pk_bf16_f32 v138, v148, v149
    v_cvt_pk_bf16_f32 v139, v150, v151
    buffer_store_dwordx4 v[136:139], v30, s[44:47], s10 offen offset:1024 sc1
    v_cvt_pk_bf16_f32 v170, v152, v153
    v_cvt_pk_bf16_f32 v171, v154, v155
    buffer_store_dwordx4 v[168:171], v31, s[44:47], s10 offen offset:2048 sc1
    v_cvt_pk_bf16_f32 v142, v156, v157
    v_cvt_pk_bf16_f32 v143, v158, v159
    buffer_store_dwordx2 v[142:143], v30, s[44:47], s11 offen offset:1024
    s_branch L_qkv_kernel_done
L_qkv_ph_4:
    s_waitcnt lgkmcnt(0)
    v_mfma_f32_32x32x16_bf16 v[128:143], v[40:43], v[36:39], v[128:143]
    v_mfma_f32_32x32x16_bf16 v[144:159], v[44:47], v[36:39], v[144:159]
    v_cvt_pk_bf16_f32 v164, v96, v97
    v_cvt_pk_bf16_f32 v165, v98, v99
    v_cvt_pk_bf16_f32 v98, v100, v101
    v_mfma_f32_32x32x16_bf16 v[128:143], v[56:59], v[52:55], v[128:143]
    v_cvt_pk_bf16_f32 v99, v102, v103
    v_cvt_pk_bf16_f32 v100, v104, v105
    v_cvt_pk_bf16_f32 v101, v106, v107
    v_mfma_f32_32x32x16_bf16 v[144:159], v[60:63], v[52:55], v[144:159]
    buffer_store_dwordx4 v[98:101], v30, s[44:47], s9 offen offset:0 sc1
    v_cvt_pk_bf16_f32 v102, v108, v109
    v_cvt_pk_bf16_f32 v103, v110, v111
    v_mfma_f32_32x32x16_bf16 v[128:143], v[72:75], v[68:71], v[128:143]
    v_cvt_pk_bf16_f32 v104, v112, v113
    v_cvt_pk_bf16_f32 v105, v114, v115
    buffer_store_dwordx4 v[102:105], v30, s[44:47], s10 offen offset:0 sc1
    v_mfma_f32_32x32x16_bf16 v[144:159], v[76:79], v[68:71], v[144:159]
    v_cvt_pk_bf16_f32 v168, v116, v117
    v_cvt_pk_bf16_f32 v169, v118, v119
    v_cvt_pk_bf16_f32 v108, v120, v121
    v_mfma_f32_32x32x16_bf16 v[128:143], v[88:91], v[84:87], v[128:143]
    v_cvt_pk_bf16_f32 v109, v122, v123
    v_cvt_pk_bf16_f32 v110, v124, v125
    v_mfma_f32_32x32x16_bf16 v[144:159], v[92:95], v[84:87], v[144:159]
    v_cvt_pk_bf16_f32 v111, v126, v127
    buffer_store_dwordx4 v[108:111], v30, s[44:47], s11 offen offset:0 sc1
    s_nop 7
    v_cvt_pk_bf16_f32 v166, v128, v129
    v_cvt_pk_bf16_f32 v167, v130, v131
    buffer_store_dwordx4 v[164:167], v31, s[44:47], s8 offen offset:2048 sc1
    v_cvt_pk_bf16_f32 v130, v132, v133
    v_cvt_pk_bf16_f32 v131, v134, v135
    v_cvt_pk_bf16_f32 v132, v136, v137
    v_cvt_pk_bf16_f32 v133, v138, v139
    buffer_store_dwordx4 v[130:133], v30, s[44:47], s9 offen offset:1024 sc1
    v_cvt_pk_bf16_f32 v134, v140, v141
    v_cvt_pk_bf16_f32 v135, v142, v143
    v_cvt_pk_bf16_f32 v136, v144, v145
    v_cvt_pk_bf16_f32 v137, v146, v147
    buffer_store_dwordx4 v[134:137], v30, s[44:47], s10 offen offset:1024 sc1
    v_cvt_pk_bf16_f32 v170, v148, v149
    v_cvt_pk_bf16_f32 v171, v150, v151
    buffer_store_dwordx4 v[168:171], v31, s[44:47], s10 offen offset:2048 sc1
    v_cvt_pk_bf16_f32 v140, v152, v153
    v_cvt_pk_bf16_f32 v141, v154, v155
    v_cvt_pk_bf16_f32 v142, v156, v157
    v_cvt_pk_bf16_f32 v143, v158, v159
    buffer_store_dwordx4 v[140:143], v30, s[44:47], s11 offen offset:1024 sc1
    s_branch L_qkv_kernel_done
L_qkv_ph_5:
    s_waitcnt lgkmcnt(0)
    v_mfma_f32_32x32x16_bf16 v[128:143], v[40:43], v[36:39], v[128:143]
    v_mfma_f32_32x32x16_bf16 v[144:159], v[44:47], v[36:39], v[144:159]
    v_cvt_pk_bf16_f32 v96, v96, v97
    v_cvt_pk_bf16_f32 v97, v98, v99
    v_cvt_pk_bf16_f32 v98, v100, v101
    v_mfma_f32_32x32x16_bf16 v[128:143], v[56:59], v[52:55], v[128:143]
    v_cvt_pk_bf16_f32 v99, v102, v103
    buffer_store_dwordx4 v[96:99], v30, s[44:47], s9 offen offset:0 sc1
    v_cvt_pk_bf16_f32 v100, v104, v105
    v_mfma_f32_32x32x16_bf16 v[144:159], v[60:63], v[52:55], v[144:159]
    v_cvt_pk_bf16_f32 v101, v106, v107
    v_cvt_pk_bf16_f32 v102, v108, v109
    v_cvt_pk_bf16_f32 v103, v110, v111
    v_mfma_f32_32x32x16_bf16 v[128:143], v[72:75], v[68:71], v[128:143]
    buffer_store_dwordx4 v[100:103], v30, s[44:47], s10 offen offset:0 sc1
    v_cvt_pk_bf16_f32 v164, v112, v113
    v_cvt_pk_bf16_f32 v165, v114, v115
    v_mfma_f32_32x32x16_bf16 v[144:159], v[76:79], v[68:71], v[144:159]
    v_cvt_pk_bf16_f32 v106, v116, v117
    v_cvt_pk_bf16_f32 v107, v118, v119
    v_cvt_pk_bf16_f32 v108, v120, v121
    v_mfma_f32_32x32x16_bf16 v[128:143], v[88:91], v[84:87], v[128:143]
    v_cvt_pk_bf16_f32 v109, v122, v123
    buffer_store_dwordx4 v[106:109], v30, s[44:47], s11 offen offset:0 sc1
    v_cvt_pk_bf16_f32 v110, v124, v125
    v_mfma_f32_32x32x16_bf16 v[144:159], v[92:95], v[84:87], v[144:159]
    v_cvt_pk_bf16_f32 v111, v126, v127
    buffer_store_dwordx2 v[110:111], v30, s[44:47], s12 offen offset:0
    s_nop 7
    v_cvt_pk_bf16_f32 v128, v128, v129
    v_cvt_pk_bf16_f32 v129, v130, v131
    v_cvt_pk_bf16_f32 v130, v132, v133
    v_cvt_pk_bf16_f32 v131, v134, v135
    buffer_store_dwordx4 v[128:131], v30, s[44:47], s9 offen offset:1024 sc1
    v_cvt_pk_bf16_f32 v132, v136, v137
    v_cvt_pk_bf16_f32 v133, v138, v139
    v_cvt_pk_bf16_f32 v134, v140, v141
    v_cvt_pk_bf16_f32 v135, v142, v143
    buffer_store_dwordx4 v[132:135], v30, s[44:47], s10 offen offset:1024 sc1
    v_cvt_pk_bf16_f32 v166, v144, v145
    v_cvt_pk_bf16_f32 v167, v146, v147
    buffer_store_dwordx4 v[164:167], v31, s[44:47], s10 offen offset:2048 sc1
    v_cvt_pk_bf16_f32 v138, v148, v149
    v_cvt_pk_bf16_f32 v139, v150, v151
    v_cvt_pk_bf16_f32 v140, v152, v153
    v_cvt_pk_bf16_f32 v141, v154, v155
    buffer_store_dwordx4 v[138:141], v30, s[44:47], s11 offen offset:1024 sc1
    v_cvt_pk_bf16_f32 v142, v156, v157
    v_cvt_pk_bf16_f32 v143, v158, v159
    buffer_store_dwordx2 v[142:143], v30, s[44:47], s12 offen offset:1024
    s_branch L_qkv_kernel_done
L_qkv_ph_6:
    s_waitcnt lgkmcnt(0)
    v_mfma_f32_32x32x16_bf16 v[128:143], v[40:43], v[36:39], v[128:143]
    v_mfma_f32_32x32x16_bf16 v[144:159], v[44:47], v[36:39], v[144:159]
    v_cvt_pk_bf16_f32 v96, v96, v97
    v_cvt_pk_bf16_f32 v97, v98, v99
    buffer_store_dwordx2 v[96:97], v30, s[44:47], s9 offen offset:8
    v_mfma_f32_32x32x16_bf16 v[128:143], v[56:59], v[52:55], v[128:143]
    v_cvt_pk_bf16_f32 v98, v100, v101
    v_cvt_pk_bf16_f32 v99, v102, v103
    v_cvt_pk_bf16_f32 v100, v104, v105
    v_mfma_f32_32x32x16_bf16 v[144:159], v[60:63], v[52:55], v[144:159]
    v_cvt_pk_bf16_f32 v101, v106, v107
    buffer_store_dwordx4 v[98:101], v30, s[44:47], s10 offen offset:0 sc1
    v_cvt_pk_bf16_f32 v164, v108, v109
    v_mfma_f32_32x32x16_bf16 v[128:143], v[72:75], v[68:71], v[128:143]
    v_cvt_pk_bf16_f32 v165, v110, v111
    v_cvt_pk_bf16_f32 v104, v112, v113
    v_cvt_pk_bf16_f32 v105, v114, v115
    v_mfma_f32_32x32x16_bf16 v[144:159], v[76:79], v[68:71], v[144:159]
    v_cvt_pk_bf16_f32 v106, v116, v117
    v_cvt_pk_bf16_f32 v107, v118, v119
    buffer_store_dwordx4 v[104:107], v30, s[44:47], s11 offen offset:0 sc1
    v_mfma_f32_32x32x16_bf16 v[128:143], v[88:91], v[84:87], v[128:143]
    v_cvt_pk_bf16_f32 v108, v120, v121
    v_cvt_pk_bf16_f32 v109, v122, v123
    v_cvt_pk_bf16_f32 v110, v124, v125
    v_mfma_f32_32x32x16_bf16 v[144:159], v[92:95], v[84:87], v[144:159]
    v_cvt_pk_bf16_f32 v111, v126, v127
    buffer_store_dwordx4 v[108:111], v30, s[44:47], s12 offen offset:0 sc1
    s_nop 7
    v_cvt_pk_bf16_f32 v128, v128, v129
    v_cvt_pk_bf16_f32 v129, v130, v131
    buffer_store_dwordx2 v[128:129], v30, s[44:47], s9 offen offset:1032
    v_cvt_pk_bf16_f32 v130, v132, v133
    v_cvt_pk_bf16_f32 v131, v134, v135
    v_cvt_pk_bf16_f32 v132, v136, v137
    v_cvt_pk_bf16_f32 v133, v138, v139
    buffer_store_dwordx4 v[130:133], v30, s[44:47], s10 offen offset:1024 sc1
    v_cvt_pk_bf16_f32 v166, v140, v141
    v_cvt_pk_bf16_f32 v167, v142, v143
    buffer_store_dwordx4 v[164:167], v31, s[44:47], s10 offen offset:2048 sc1
    v_cvt_pk_bf16_f32 v136, v144, v145
    v_cvt_pk_bf16_f32 v137, v146, v147
    v_cvt_pk_bf16_f32 v138, v148, v149
    v_cvt_pk_bf16_f32 v139, v150, v151
    buffer_store_dwordx4 v[136:139], v30, s[44:47], s11 offen offset:1024 sc1
    v_cvt_pk_bf16_f32 v140, v152, v153
    v_cvt_pk_bf16_f32 v141, v154, v155
    v_cvt_pk_bf16_f32 v142, v156, v157
    v_cvt_pk_bf16_f32 v143, v158, v159
    buffer_store_dwordx4 v[140:143], v30, s[44:47], s12 offen offset:1024 sc1
    s_branch L_qkv_kernel_done
L_qkv_v_1:
    s_mul_i32 s52, s52, 5120
    s_add_u32 s59, s52, 2560
    s_sub_u32 s53, s49, 10
    s_lshl_b32 s53, s53, 7
    s_lshl_b32 s52, s51, 6
    s_add_u32 s53, s53, s52
    s_mov_b32 s57, 163840
    v_mul_u32_u24 v27, 320, v23
    v_add_u32 v25, s53, v22
    v_mul_u32_u24 v26, 3277, v25
    v_lshrrev_b32 v26, 16, v26
    v_mul_u32_u24 v28, 20, v26
    v_sub_u32 v25, v25, v28
    v_mul_u32_u24 v26, s57, v26
    v_lshl_add_u32 v26, v25, 4, v26
    v_add3_u32 v30, v26, v27, s59
    v_add_u32 v25, s53, v22
    v_add_u32 v25, 32, v25
    v_mul_u32_u24 v26, 3277, v25
    v_lshrrev_b32 v26, 16, v26
    v_mul_u32_u24 v28, 20, v26
    v_sub_u32 v25, v25, v28
    v_mul_u32_u24 v26, s57, v26
    v_lshl_add_u32 v26, v25, 4, v26
    v_add3_u32 v31, v26, v27, s59
    s_waitcnt vmcnt(0)
    s_add_u32 m0, s56, 32768
    s_movk_i32 s54, 128
    buffer_load_dwordx4 v2, s[36:39], s54 offen offset:0 lds
    buffer_load_dwordx4 v3, s[36:39], s54 offen offset:1024 lds
    buffer_load_dwordx4 v4, s[36:39], s54 offen offset:2048 lds
    buffer_load_dwordx4 v5, s[36:39], s54 offen offset:3072 lds
    s_add_u32 m0, s56, 49152
    s_mov_b32 s55, 245760
    buffer_load_dwordx4 v6, s[40:43], s55 offen offset:0 lds
    buffer_load_dwordx4 v7, s[40:43], s55 offen offset:1024 lds
    buffer_load_dwordx4 v8, s[40:43], s55 offen offset:2048 lds
    buffer_load_dwordx4 v9, s[40:43], s55 offen offset:3072 lds
    s_add_u32 m0, s56, 65536
    s_movk_i32 s54, 256
    buffer_load_dwordx4 v2, s[36:39], s54 offen offset:0 lds
    buffer_load_dwordx4 v3, s[36:39], s54 offen offset:1024 lds
    buffer_load_dwordx4 v4, s[36:39], s54 offen offset:2048 lds
    buffer_load_dwordx4 v5, s[36:39], s54 offen offset:3072 lds
    s_barrier
    s_add_u32 m0, s56, 81920
    s_mov_b32 s55, 491520
    buffer_load_dwordx4 v6, s[40:43], s55 offen offset:0 lds
    buffer_load_dwordx4 v7, s[40:43], s55 offen offset:1024 lds
    buffer_load_dwordx4 v8, s[40:43], s55 offen offset:2048 lds
    buffer_load_dwordx4 v9, s[40:43], s55 offen offset:3072 lds
    s_waitcnt vmcnt(16) lgkmcnt(0)
    s_barrier
    ds_read_b128 v[32:35], v10 offset:0
    ds_read_b64_tr_b16 v[40:41], v18 offset:0
    ds_read_b64_tr_b16 v[42:43], v18 offset:1024
    ds_read_b64_tr_b16 v[44:45], v19 offset:0
    ds_read_b64_tr_b16 v[46:47], v19 offset:1024
    ds_read_b128 v[36:39], v10 offset:4096
    ds_read_b128 v[48:51], v11 offset:0
    ds_read_b64_tr_b16 v[56:57], v18 offset:4096
    ds_read_b64_tr_b16 v[58:59], v18 offset:5120
    ds_read_b64_tr_b16 v[60:61], v19 offset:4096
    ds_read_b64_tr_b16 v[62:63], v19 offset:5120
    ds_read_b128 v[52:55], v11 offset:4096
    s_waitcnt lgkmcnt(6)
    v_mfma_f32_32x32x16_bf16 v[96:111], v[32:35], v[40:43], 0
    ds_read_b128 v[64:67], v12 offset:0
    ds_read_b64_tr_b16 v[72:73], v18 offset:8192
    s_add_u32 m0, s56, 98304
    s_movk_i32 s54, 384
    buffer_load_dwordx4 v2, s[36:39], s54 offen offset:0 lds
    v_mfma_f32_32x32x16_bf16 v[112:127], v[32:35], v[44:47], 0
    ds_read_b64_tr_b16 v[74:75], v18 offset:9216
    ds_read_b64_tr_b16 v[76:77], v19 offset:8192
    buffer_load_dwordx4 v3, s[36:39], s54 offen offset:1024 lds
    v_mfma_f32_32x32x16_bf16 v[128:143], v[36:39], v[40:43], 0
    ds_read_b64_tr_b16 v[78:79], v19 offset:9216
    ds_read_b128 v[68:71], v12 offset:4096
    buffer_load_dwordx4 v4, s[36:39], s54 offen offset:2048 lds
    v_mfma_f32_32x32x16_bf16 v[144:159], v[36:39], v[44:47], 0
    buffer_load_dwordx4 v5, s[36:39], s54 offen offset:3072 lds
    s_waitcnt lgkmcnt(6)
    v_mfma_f32_32x32x16_bf16 v[96:111], v[48:51], v[56:59], v[96:111]
    ds_read_b128 v[80:83], v13 offset:0
    ds_read_b64_tr_b16 v[88:89], v18 offset:12288
    ds_read_b64_tr_b16 v[90:91], v18 offset:13312
    s_add_u32 m0, s56, 114688
    s_mov_b32 s55, 737280
    buffer_load_dwordx4 v6, s[40:43], s55 offen offset:0 lds
    v_mfma_f32_32x32x16_bf16 v[112:127], v[48:51], v[60:63], v[112:127]
    ds_read_b64_tr_b16 v[92:93], v19 offset:12288
    ds_read_b64_tr_b16 v[94:95], v19 offset:13312
    ds_read_b128 v[84:87], v13 offset:4096
    buffer_load_dwordx4 v7, s[40:43], s55 offen offset:1024 lds
    v_mfma_f32_32x32x16_bf16 v[128:143], v[52:55], v[56:59], v[128:143]
    buffer_load_dwordx4 v8, s[40:43], s55 offen offset:2048 lds
    v_mfma_f32_32x32x16_bf16 v[144:159], v[52:55], v[60:63], v[144:159]
    buffer_load_dwordx4 v9, s[40:43], s55 offen offset:3072 lds
    s_waitcnt vmcnt(16) lgkmcnt(0)
    s_barrier
    v_mfma_f32_32x32x16_bf16 v[96:111], v[64:67], v[72:75], v[96:111]
    ds_read_b128 v[32:35], v10 offset:32768
    ds_read_b64_tr_b16 v[40:41], v18 offset:32768
    v_mfma_f32_32x32x16_bf16 v[112:127], v[64:67], v[76:79], v[112:127]
    ds_read_b64_tr_b16 v[42:43], v18 offset:33792
    ds_read_b64_tr_b16 v[44:45], v19 offset:32768
    s_add_u32 m0, s56, 0
    s_movk_i32 s54, 512
    buffer_load_dwordx4 v2, s[36:39], s54 offen offset:0 lds
    v_mfma_f32_32x32x16_bf16 v[128:143], v[68:71], v[72:75], v[128:143]
    ds_read_b64_tr_b16 v[46:47], v19 offset:33792
    ds_read_b128 v[36:39], v10 offset:36864
    v_mfma_f32_32x32x16_bf16 v[144:159], v[68:71], v[76:79], v[144:159]
    buffer_load_dwordx4 v3, s[36:39], s54 offen offset:1024 lds
    v_mfma_f32_32x32x16_bf16 v[96:111], v[80:83], v[88:91], v[96:111]
    ds_read_b128 v[48:51], v11 offset:32768
    ds_read_b64_tr_b16 v[56:57], v18 offset:36864
    v_mfma_f32_32x32x16_bf16 v[112:127], v[80:83], v[92:95], v[112:127]
    ds_read_b64_tr_b16 v[58:59], v18 offset:37888
    ds_read_b64_tr_b16 v[60:61], v19 offset:36864
    buffer_load_dwordx4 v4, s[36:39], s54 offen offset:2048 lds
    v_mfma_f32_32x32x16_bf16 v[128:143], v[84:87], v[88:91], v[128:143]
    ds_read_b64_tr_b16 v[62:63], v19 offset:37888
    ds_read_b128 v[52:55], v11 offset:36864
    v_mfma_f32_32x32x16_bf16 v[144:159], v[84:87], v[92:95], v[144:159]
    buffer_load_dwordx4 v5, s[36:39], s54 offen offset:3072 lds
    s_waitcnt lgkmcnt(6)
    v_mfma_f32_32x32x16_bf16 v[96:111], v[32:35], v[40:43], v[96:111]
    ds_read_b128 v[64:67], v12 offset:32768
    ds_read_b64_tr_b16 v[72:73], v18 offset:40960
    v_mfma_f32_32x32x16_bf16 v[112:127], v[32:35], v[44:47], v[112:127]
    ds_read_b64_tr_b16 v[74:75], v18 offset:41984
    ds_read_b64_tr_b16 v[76:77], v19 offset:40960
    s_add_u32 m0, s56, 16384
    s_mov_b32 s55, 983040
    buffer_load_dwordx4 v6, s[40:43], s55 offen offset:0 lds
    v_mfma_f32_32x32x16_bf16 v[128:143], v[36:39], v[40:43], v[128:143]
    ds_read_b64_tr_b16 v[78:79], v19 offset:41984
    ds_read_b128 v[68:71], v12 offset:36864
    v_mfma_f32_32x32x16_bf16 v[144:159], v[36:39], v[44:47], v[144:159]
    buffer_load_dwordx4 v7, s[40:43], s55 offen offset:1024 lds
    s_waitcnt lgkmcnt(6)
    v_mfma_f32_32x32x16_bf16 v[96:111], v[48:51], v[56:59], v[96:111]
    ds_read_b128 v[80:83], v13 offset:32768
    ds_read_b64_tr_b16 v[88:89], v18 offset:45056
    ds_read_b64_tr_b16 v[90:91], v18 offset:46080
    v_mfma_f32_32x32x16_bf16 v[112:127], v[48:51], v[60:63], v[112:127]
    ds_read_b64_tr_b16 v[92:93], v19 offset:45056
    ds_read_b64_tr_b16 v[94:95], v19 offset:46080
    ds_read_b128 v[84:87], v13 offset:36864
    buffer_load_dwordx4 v8, s[40:43], s55 offen offset:2048 lds
    v_mfma_f32_32x32x16_bf16 v[128:143], v[52:55], v[56:59], v[128:143]
    v_mfma_f32_32x32x16_bf16 v[144:159], v[52:55], v[60:63], v[144:159]
    buffer_load_dwordx4 v9, s[40:43], s55 offen offset:3072 lds
    s_waitcnt vmcnt(16) lgkmcnt(0)
    s_barrier
    v_mfma_f32_32x32x16_bf16 v[96:111], v[64:67], v[72:75], v[96:111]
    ds_read_b128 v[32:35], v14 offset:0
    ds_read_b64_tr_b16 v[40:41], v20 offset:0
    v_mfma_f32_32x32x16_bf16 v[112:127], v[64:67], v[76:79], v[112:127]
    ds_read_b64_tr_b16 v[42:43], v20 offset:1024
    ds_read_b64_tr_b16 v[44:45], v21 offset:0
    s_add_u32 m0, s56, 32768
    s_movk_i32 s54, 640
    buffer_load_dwordx4 v2, s[36:39], s54 offen offset:0 lds
    v_mfma_f32_32x32x16_bf16 v[128:143], v[68:71], v[72:75], v[128:143]
    ds_read_b64_tr_b16 v[46:47], v21 offset:1024
    ds_read_b128 v[36:39], v14 offset:4096
    v_mfma_f32_32x32x16_bf16 v[144:159], v[68:71], v[76:79], v[144:159]
    buffer_load_dwordx4 v3, s[36:39], s54 offen offset:1024 lds
    v_mfma_f32_32x32x16_bf16 v[96:111], v[80:83], v[88:91], v[96:111]
    ds_read_b128 v[48:51], v15 offset:0
    ds_read_b64_tr_b16 v[56:57], v20 offset:4096
    v_mfma_f32_32x32x16_bf16 v[112:127], v[80:83], v[92:95], v[112:127]
    ds_read_b64_tr_b16 v[58:59], v20 offset:5120
    ds_read_b64_tr_b16 v[60:61], v21 offset:4096
    buffer_load_dwordx4 v4, s[36:39], s54 offen offset:2048 lds
    v_mfma_f32_32x32x16_bf16 v[128:143], v[84:87], v[88:91], v[128:143]
    ds_read_b64_tr_b16 v[62:63], v21 offset:5120
    ds_read_b128 v[52:55], v15 offset:4096
    v_mfma_f32_32x32x16_bf16 v[144:159], v[84:87], v[92:95], v[144:159]
    buffer_load_dwordx4 v5, s[36:39], s54 offen offset:3072 lds
    s_waitcnt lgkmcnt(6)
    v_mfma_f32_32x32x16_bf16 v[96:111], v[32:35], v[40:43], v[96:111]
    ds_read_b128 v[64:67], v16 offset:0
    ds_read_b64_tr_b16 v[72:73], v20 offset:8192
    v_mfma_f32_32x32x16_bf16 v[112:127], v[32:35], v[44:47], v[112:127]
    ds_read_b64_tr_b16 v[74:75], v20 offset:9216
    ds_read_b64_tr_b16 v[76:77], v21 offset:8192
    s_add_u32 m0, s56, 49152
    s_mov_b32 s55, 1228800
    buffer_load_dwordx4 v6, s[40:43], s55 offen offset:0 lds
    v_mfma_f32_32x32x16_bf16 v[128:143], v[36:39], v[40:43], v[128:143]
    ds_read_b64_tr_b16 v[78:79], v21 offset:9216
    ds_read_b128 v[68:71], v16 offset:4096
    v_mfma_f32_32x32x16_bf16 v[144:159], v[36:39], v[44:47], v[144:159]
    buffer_load_dwordx4 v7, s[40:43], s55 offen offset:1024 lds
    s_waitcnt lgkmcnt(6)
    v_mfma_f32_32x32x16_bf16 v[96:111], v[48:51], v[56:59], v[96:111]
    ds_read_b128 v[80:83], v17 offset:0
    ds_read_b64_tr_b16 v[88:89], v20 offset:12288
    ds_read_b64_tr_b16 v[90:91], v20 offset:13312
    v_mfma_f32_32x32x16_bf16 v[112:127], v[48:51], v[60:63], v[112:127]
    ds_read_b64_tr_b16 v[92:93], v21 offset:12288
    ds_read_b64_tr_b16 v[94:95], v21 offset:13312
    ds_read_b128 v[84:87], v17 offset:4096
    buffer_load_dwordx4 v8, s[40:43], s55 offen offset:2048 lds
    v_mfma_f32_32x32x16_bf16 v[128:143], v[52:55], v[56:59], v[128:143]
    v_mfma_f32_32x32x16_bf16 v[144:159], v[52:55], v[60:63], v[144:159]
    buffer_load_dwordx4 v9, s[40:43], s55 offen offset:3072 lds
    s_waitcnt vmcnt(16) lgkmcnt(0)
    s_barrier
    v_mfma_f32_32x32x16_bf16 v[96:111], v[64:67], v[72:75], v[96:111]
    ds_read_b128 v[32:35], v14 offset:32768
    ds_read_b64_tr_b16 v[40:41], v20 offset:32768
    s_add_u32 m0, s56, 65536
    s_movk_i32 s54, 768
    buffer_load_dwordx4 v2, s[36:39], s54 offen offset:0 lds
    v_mfma_f32_32x32x16_bf16 v[112:127], v[64:67], v[76:79], v[112:127]
    ds_read_b64_tr_b16 v[42:43], v20 offset:33792
    ds_read_b64_tr_b16 v[44:45], v21 offset:32768
    v_mfma_f32_32x32x16_bf16 v[128:143], v[68:71], v[72:75], v[128:143]
    ds_read_b64_tr_b16 v[46:47], v21 offset:33792
    ds_read_b128 v[36:39], v14 offset:36864
    buffer_load_dwordx4 v3, s[36:39], s54 offen offset:1024 lds
    v_mfma_f32_32x32x16_bf16 v[144:159], v[68:71], v[76:79], v[144:159]
    buffer_load_dwordx4 v4, s[36:39], s54 offen offset:2048 lds
    v_mfma_f32_32x32x16_bf16 v[96:111], v[80:83], v[88:91], v[96:111]
    ds_read_b128 v[48:51], v15 offset:32768
    ds_read_b64_tr_b16 v[56:57], v20 offset:36864
    buffer_load_dwordx4 v5, s[36:39], s54 offen offset:3072 lds
    v_mfma_f32_32x32x16_bf16 v[112:127], v[80:83], v[92:95], v[112:127]
    ds_read_b64_tr_b16 v[58:59], v20 offset:37888
    ds_read_b64_tr_b16 v[60:61], v21 offset:36864
    v_mfma_f32_32x32x16_bf16 v[128:143], v[84:87], v[88:91], v[128:143]
    ds_read_b64_tr_b16 v[62:63], v21 offset:37888
    ds_read_b128 v[52:55], v15 offset:36864
    s_add_u32 m0, s56, 81920
    s_mov_b32 s55, 1474560
    buffer_load_dwordx4 v6, s[40:43], s55 offen offset:0 lds
    v_mfma_f32_32x32x16_bf16 v[144:159], v[84:87], v[92:95], v[144:159]
    buffer_load_dwordx4 v7, s[40:43], s55 offen offset:1024 lds
    s_waitcnt lgkmcnt(6)
    v_mfma_f32_32x32x16_bf16 v[96:111], v[32:35], v[40:43], v[96:111]
    ds_read_b128 v[64:67], v16 offset:32768
    ds_read_b64_tr_b16 v[72:73], v20 offset:40960
    buffer_load_dwordx4 v8, s[40:43], s55 offen offset:2048 lds
    v_mfma_f32_32x32x16_bf16 v[112:127], v[32:35], v[44:47], v[112:127]
    ds_read_b64_tr_b16 v[74:75], v20 offset:41984
    ds_read_b64_tr_b16 v[76:77], v21 offset:40960
    v_mfma_f32_32x32x16_bf16 v[128:143], v[36:39], v[40:43], v[128:143]
    ds_read_b64_tr_b16 v[78:79], v21 offset:41984
    ds_read_b128 v[68:71], v16 offset:36864
    buffer_load_dwordx4 v9, s[40:43], s55 offen offset:3072 lds
    v_mfma_f32_32x32x16_bf16 v[144:159], v[36:39], v[44:47], v[144:159]
    s_add_u32 m0, s56, 131072
    s_nop 0
    buffer_load_dwordx4 v160, s[64:67], s68 offen nt lds
    s_waitcnt lgkmcnt(6)
    v_mfma_f32_32x32x16_bf16 v[96:111], v[48:51], v[56:59], v[96:111]
    ds_read_b128 v[80:83], v17 offset:32768
    ds_read_b64_tr_b16 v[88:89], v20 offset:45056
    ds_read_b64_tr_b16 v[90:91], v20 offset:46080
    s_add_u32 m0, s56, 132096
    s_add_u32 s68, s68, 983040
    buffer_load_dwordx4 v160, s[64:67], s68 offen nt lds
    v_mfma_f32_32x32x16_bf16 v[112:127], v[48:51], v[60:63], v[112:127]
    ds_read_b64_tr_b16 v[92:93], v21 offset:45056
    ds_read_b64_tr_b16 v[94:95], v21 offset:46080
    ds_read_b128 v[84:87], v17 offset:36864
    v_mfma_f32_32x32x16_bf16 v[128:143], v[52:55], v[56:59], v[128:143]
    s_add_u32 m0, s56, 133120
    s_add_u32 s68, s68, s62
    buffer_load_dwordx4 v160, s[64:67], s68 offen nt lds
    v_mfma_f32_32x32x16_bf16 v[144:159], v[52:55], v[60:63], v[144:159]
    s_waitcnt vmcnt(19) lgkmcnt(0)
    s_barrier
    v_mfma_f32_32x32x16_bf16 v[96:111], v[64:67], v[72:75], v[96:111]
    ds_read_b128 v[32:35], v10 offset:0
    ds_read_b64_tr_b16 v[40:41], v18 offset:0
    v_mfma_f32_32x32x16_bf16 v[112:127], v[64:67], v[76:79], v[112:127]
    ds_read_b64_tr_b16 v[42:43], v18 offset:1024
    ds_read_b64_tr_b16 v[44:45], v19 offset:0
    s_add_u32 m0, s56, 98304
    s_movk_i32 s54, 896
    buffer_load_dwordx4 v2, s[36:39], s54 offen offset:0 lds
    v_mfma_f32_32x32x16_bf16 v[128:143], v[68:71], v[72:75], v[128:143]
    ds_read_b64_tr_b16 v[46:47], v19 offset:1024
    ds_read_b128 v[36:39], v10 offset:4096
    v_mfma_f32_32x32x16_bf16 v[144:159], v[68:71], v[76:79], v[144:159]
    buffer_load_dwordx4 v3, s[36:39], s54 offen offset:1024 lds
    v_mfma_f32_32x32x16_bf16 v[96:111], v[80:83], v[88:91], v[96:111]
    ds_read_b128 v[48:51], v11 offset:0
    ds_read_b64_tr_b16 v[56:57], v18 offset:4096
    v_mfma_f32_32x32x16_bf16 v[112:127], v[80:83], v[92:95], v[112:127]
    ds_read_b64_tr_b16 v[58:59], v18 offset:5120
    ds_read_b64_tr_b16 v[60:61], v19 offset:4096
    buffer_load_dwordx4 v4, s[36:39], s54 offen offset:2048 lds
    v_mfma_f32_32x32x16_bf16 v[128:143], v[84:87], v[88:91], v[128:143]
    ds_read_b64_tr_b16 v[62:63], v19 offset:5120
    ds_read_b128 v[52:55], v11 offset:4096
    v_mfma_f32_32x32x16_bf16 v[144:159], v[84:87], v[92:95], v[144:159]
    buffer_load_dwordx4 v5, s[36:39], s54 offen offset:3072 lds
    s_waitcnt lgkmcnt(6)
    v_mfma_f32_32x32x16_bf16 v[96:111], v[32:35], v[40:43], v[96:111]
    ds_read_b128 v[64:67], v12 offset:0
    ds_read_b64_tr_b16 v[72:73], v18 offset:8192
    v_mfma_f32_32x32x16_bf16 v[112:127], v[32:35], v[44:47], v[112:127]
    ds_read_b64_tr_b16 v[74:75], v18 offset:9216
    ds_read_b64_tr_b16 v[76:77], v19 offset:8192
    s_add_u32 m0, s56, 114688
    s_mov_b32 s55, 1720320
    buffer_load_dwordx4 v6, s[40:43], s55 offen offset:0 lds
    v_mfma_f32_32x32x16_bf16 v[128:143], v[36:39], v[40:43], v[128:143]
    ds_read_b64_tr_b16 v[78:79], v19 offset:9216
    ds_read_b128 v[68:71], v12 offset:4096
    v_mfma_f32_32x32x16_bf16 v[144:159], v[36:39], v[44:47], v[144:159]
    buffer_load_dwordx4 v7, s[40:43], s55 offen offset:1024 lds
    s_waitcnt lgkmcnt(6)
    v_mfma_f32_32x32x16_bf16 v[96:111], v[48:51], v[56:59], v[96:111]
    ds_read_b128 v[80:83], v13 offset:0
    ds_read_b64_tr_b16 v[88:89], v18 offset:12288
    ds_read_b64_tr_b16 v[90:91], v18 offset:13312
    v_mfma_f32_32x32x16_bf16 v[112:127], v[48:51], v[60:63], v[112:127]
    ds_read_b64_tr_b16 v[92:93], v19 offset:12288
    ds_read_b64_tr_b16 v[94:95], v19 offset:13312
    ds_read_b128 v[84:87], v13 offset:4096
    buffer_load_dwordx4 v8, s[40:43], s55 offen offset:2048 lds
    v_mfma_f32_32x32x16_bf16 v[128:143], v[52:55], v[56:59], v[128:143]
    v_mfma_f32_32x32x16_bf16 v[144:159], v[52:55], v[60:63], v[144:159]
    buffer_load_dwordx4 v9, s[40:43], s55 offen offset:3072 lds
    s_waitcnt vmcnt(19) lgkmcnt(0)
    s_barrier
    v_mfma_f32_32x32x16_bf16 v[96:111], v[64:67], v[72:75], v[96:111]
    ds_read_b128 v[32:35], v10 offset:32768
    ds_read_b64_tr_b16 v[40:41], v18 offset:32768
    v_mfma_f32_32x32x16_bf16 v[112:127], v[64:67], v[76:79], v[112:127]
    ds_read_b64_tr_b16 v[42:43], v18 offset:33792
    ds_read_b64_tr_b16 v[44:45], v19 offset:32768
    s_add_u32 m0, s56, 0
    s_movk_i32 s54, 1024
    buffer_load_dwordx4 v2, s[36:39], s54 offen offset:0 lds
    v_mfma_f32_32x32x16_bf16 v[128:143], v[68:71], v[72:75], v[128:143]
    ds_read_b64_tr_b16 v[46:47], v19 offset:33792
    ds_read_b128 v[36:39], v10 offset:36864
    v_mfma_f32_32x32x16_bf16 v[144:159], v[68:71], v[76:79], v[144:159]
    buffer_load_dwordx4 v3, s[36:39], s54 offen offset:1024 lds
    v_mfma_f32_32x32x16_bf16 v[96:111], v[80:83], v[88:91], v[96:111]
    ds_read_b128 v[48:51], v11 offset:32768
    ds_read_b64_tr_b16 v[56:57], v18 offset:36864
    v_mfma_f32_32x32x16_bf16 v[112:127], v[80:83], v[92:95], v[112:127]
    ds_read_b64_tr_b16 v[58:59], v18 offset:37888
    ds_read_b64_tr_b16 v[60:61], v19 offset:36864
    buffer_load_dwordx4 v4, s[36:39], s54 offen offset:2048 lds
    v_mfma_f32_32x32x16_bf16 v[128:143], v[84:87], v[88:91], v[128:143]
    ds_read_b64_tr_b16 v[62:63], v19 offset:37888
    ds_read_b128 v[52:55], v11 offset:36864
    v_mfma_f32_32x32x16_bf16 v[144:159], v[84:87], v[92:95], v[144:159]
    buffer_load_dwordx4 v5, s[36:39], s54 offen offset:3072 lds
    s_waitcnt lgkmcnt(6)
    v_mfma_f32_32x32x16_bf16 v[96:111], v[32:35], v[40:43], v[96:111]
    ds_read_b128 v[64:67], v12 offset:32768
    ds_read_b64_tr_b16 v[72:73], v18 offset:40960
    v_mfma_f32_32x32x16_bf16 v[112:127], v[32:35], v[44:47], v[112:127]
    ds_read_b64_tr_b16 v[74:75], v18 offset:41984
    ds_read_b64_tr_b16 v[76:77], v19 offset:40960
    s_add_u32 m0, s56, 16384
    s_mov_b32 s55, 1966080
    buffer_load_dwordx4 v6, s[40:43], s55 offen offset:0 lds
    v_mfma_f32_32x32x16_bf16 v[128:143], v[36:39], v[40:43], v[128:143]
    ds_read_b64_tr_b16 v[78:79], v19 offset:41984
    ds_read_b128 v[68:71], v12 offset:36864
    v_mfma_f32_32x32x16_bf16 v[144:159], v[36:39], v[44:47], v[144:159]
    buffer_load_dwordx4 v7, s[40:43], s55 offen offset:1024 lds
    s_waitcnt lgkmcnt(6)
    v_mfma_f32_32x32x16_bf16 v[96:111], v[48:51], v[56:59], v[96:111]
    ds_read_b128 v[80:83], v13 offset:32768
    ds_read_b64_tr_b16 v[88:89], v18 offset:45056
    ds_read_b64_tr_b16 v[90:91], v18 offset:46080
    v_mfma_f32_32x32x16_bf16 v[112:127], v[48:51], v[60:63], v[112:127]
    ds_read_b64_tr_b16 v[92:93], v19 offset:45056
    ds_read_b64_tr_b16 v[94:95], v19 offset:46080
    ds_read_b128 v[84:87], v13 offset:36864
    buffer_load_dwordx4 v8, s[40:43], s55 offen offset:2048 lds
    v_mfma_f32_32x32x16_bf16 v[128:143], v[52:55], v[56:59], v[128:143]
    v_mfma_f32_32x32x16_bf16 v[144:159], v[52:55], v[60:63], v[144:159]
    buffer_load_dwordx4 v9, s[40:43], s55 offen offset:3072 lds
    s_waitcnt vmcnt(19) lgkmcnt(0)
    s_barrier
    v_mfma_f32_32x32x16_bf16 v[96:111], v[64:67], v[72:75], v[96:111]
    ds_read_b128 v[32:35], v14 offset:0
    ds_read_b64_tr_b16 v[40:41], v20 offset:0
    v_mfma_f32_32x32x16_bf16 v[112:127], v[64:67], v[76:79], v[112:127]
    ds_read_b64_tr_b16 v[42:43], v20 offset:1024
    ds_read_b64_tr_b16 v[44:45], v21 offset:0
    s_add_u32 m0, s56, 32768
    s_movk_i32 s54, 1152
    buffer_load_dwordx4 v2, s[36:39], s54 offen offset:0 lds
    v_mfma_f32_32x32x16_bf16 v[128:143], v[68:71], v[72:75], v[128:143]
    ds_read_b64_tr_b16 v[46:47], v21 offset:1024
    ds_read_b128 v[36:39], v14 offset:4096
    v_mfma_f32_32x32x16_bf16 v[144:159], v[68:71], v[76:79], v[144:159]
    buffer_load_dwordx4 v3, s[36:39], s54 offen offset:1024 lds
    v_mfma_f32_32x32x16_bf16 v[96:111], v[80:83], v[88:91], v[96:111]
    ds_read_b128 v[48:51], v15 offset:0
    ds_read_b64_tr_b16 v[56:57], v20 offset:4096
    v_mfma_f32_32x32x16_bf16 v[112:127], v[80:83], v[92:95], v[112:127]
    ds_read_b64_tr_b16 v[58:59], v20 offset:5120
    ds_read_b64_tr_b16 v[60:61], v21 offset:4096
    buffer_load_dwordx4 v4, s[36:39], s54 offen offset:2048 lds
    v_mfma_f32_32x32x16_bf16 v[128:143], v[84:87], v[88:91], v[128:143]
    ds_read_b64_tr_b16 v[62:63], v21 offset:5120
    ds_read_b128 v[52:55], v15 offset:4096
    v_mfma_f32_32x32x16_bf16 v[144:159], v[84:87], v[92:95], v[144:159]
    buffer_load_dwordx4 v5, s[36:39], s54 offen offset:3072 lds
    s_waitcnt lgkmcnt(6)
    v_mfma_f32_32x32x16_bf16 v[96:111], v[32:35], v[40:43], v[96:111]
    ds_read_b128 v[64:67], v16 offset:0
    ds_read_b64_tr_b16 v[72:73], v20 offset:8192
    v_mfma_f32_32x32x16_bf16 v[112:127], v[32:35], v[44:47], v[112:127]
    ds_read_b64_tr_b16 v[74:75], v20 offset:9216
    ds_read_b64_tr_b16 v[76:77], v21 offset:8192
    s_add_u32 m0, s56, 49152
    s_mov_b32 s55, 2211840
    buffer_load_dwordx4 v6, s[40:43], s55 offen offset:0 lds
    v_mfma_f32_32x32x16_bf16 v[128:143], v[36:39], v[40:43], v[128:143]
    ds_read_b64_tr_b16 v[78:79], v21 offset:9216
    ds_read_b128 v[68:71], v16 offset:4096
    v_mfma_f32_32x32x16_bf16 v[144:159], v[36:39], v[44:47], v[144:159]
    buffer_load_dwordx4 v7, s[40:43], s55 offen offset:1024 lds
    s_waitcnt lgkmcnt(6)
    v_mfma_f32_32x32x16_bf16 v[96:111], v[48:51], v[56:59], v[96:111]
    ds_read_b128 v[80:83], v17 offset:0
    ds_read_b64_tr_b16 v[88:89], v20 offset:12288
    ds_read_b64_tr_b16 v[90:91], v20 offset:13312
    v_mfma_f32_32x32x16_bf16 v[112:127], v[48:51], v[60:63], v[112:127]
    ds_read_b64_tr_b16 v[92:93], v21 offset:12288
    ds_read_b64_tr_b16 v[94:95], v21 offset:13312
    ds_read_b128 v[84:87], v17 offset:4096
    buffer_load_dwordx4 v8, s[40:43], s55 offen offset:2048 lds
    v_mfma_f32_32x32x16_bf16 v[128:143], v[52:55], v[56:59], v[128:143]
    v_mfma_f32_32x32x16_bf16 v[144:159], v[52:55], v[60:63], v[144:159]
    buffer_load_dwordx4 v9, s[40:43], s55 offen offset:3072 lds
    s_waitcnt vmcnt(16) lgkmcnt(0)
    s_barrier
    ds_read_b64_tr_b16 v[164:165], v161 offset:0
    ds_read_b64_tr_b16 v[166:167], v161 offset:512
    ds_read_b64_tr_b16 v[168:169], v161 offset:1024
    ds_read_b64_tr_b16 v[170:171], v161 offset:1536
    ds_read_b64_tr_b16 v[172:173], v161 offset:2048
    ds_read_b64_tr_b16 v[174:175], v161 offset:2560
    v_mfma_f32_32x32x16_bf16 v[96:111], v[64:67], v[72:75], v[96:111]
    ds_read_b128 v[32:35], v14 offset:32768
    ds_read_b64_tr_b16 v[40:41], v20 offset:32768
    v_mfma_f32_32x32x16_bf16 v[112:127], v[64:67], v[76:79], v[112:127]
    ds_read_b64_tr_b16 v[42:43], v20 offset:33792
    ds_read_b64_tr_b16 v[44:45], v21 offset:32768
    v_mfma_f32_32x32x16_bf16 v[128:143], v[68:71], v[72:75], v[128:143]
    ds_read_b64_tr_b16 v[46:47], v21 offset:33792
    ds_read_b128 v[36:39], v14 offset:36864
    v_mfma_f32_32x32x16_bf16 v[144:159], v[68:71], v[76:79], v[144:159]
    v_mfma_f32_32x32x16_bf16 v[96:111], v[80:83], v[88:91], v[96:111]
    ds_read_b128 v[48:51], v15 offset:32768
    ds_read_b64_tr_b16 v[56:57], v20 offset:36864
    v_mfma_f32_32x32x16_bf16 v[112:127], v[80:83], v[92:95], v[112:127]
    ds_read_b64_tr_b16 v[58:59], v20 offset:37888
    ds_read_b64_tr_b16 v[60:61], v21 offset:36864
    v_mfma_f32_32x32x16_bf16 v[128:143], v[84:87], v[88:91], v[128:143]
    ds_read_b64_tr_b16 v[62:63], v21 offset:37888
    ds_read_b128 v[52:55], v15 offset:36864
    v_mfma_f32_32x32x16_bf16 v[144:159], v[84:87], v[92:95], v[144:159]
    s_waitcnt lgkmcnt(6)
    v_mfma_f32_32x32x16_bf16 v[96:111], v[32:35], v[40:43], v[96:111]
    ds_read_b128 v[64:67], v16 offset:32768
    ds_read_b64_tr_b16 v[72:73], v20 offset:40960
    buffer_store_dwordx4 v[164:167], v162, s[72:75], s69 offen sc1
    s_add_u32 s69, s69, 12288
    v_mfma_f32_32x32x16_bf16 v[112:127], v[32:35], v[44:47], v[112:127]
    ds_read_b64_tr_b16 v[74:75], v20 offset:41984
    ds_read_b64_tr_b16 v[76:77], v21 offset:40960
    v_mfma_f32_32x32x16_bf16 v[128:143], v[36:39], v[40:43], v[128:143]
    ds_read_b64_tr_b16 v[78:79], v21 offset:41984
    ds_read_b128 v[68:71], v16 offset:36864
    buffer_store_dwordx4 v[168:171], v162, s[72:75], s69 offen sc1
    v_mfma_f32_32x32x16_bf16 v[144:159], v[36:39], v[44:47], v[144:159]
    s_waitcnt lgkmcnt(6)
    v_mfma_f32_32x32x16_bf16 v[96:111], v[48:51], v[56:59], v[96:111]
    ds_read_b128 v[80:83], v17 offset:32768
    ds_read_b64_tr_b16 v[88:89], v20 offset:45056
    ds_read_b64_tr_b16 v[90:91], v20 offset:46080
    buffer_store_dwordx4 v[172:175], v163, s[72:75], s69 offen sc1
    v_mfma_f32_32x32x16_bf16 v[112:127], v[48:51], v[60:63], v[112:127]
    ds_read_b64_tr_b16 v[92:93], v21 offset:45056
    ds_read_b64_tr_b16 v[94:95], v21 offset:46080
    ds_read_b128 v[84:87], v17 offset:36864
    v_mfma_f32_32x32x16_bf16 v[128:143], v[52:55], v[56:59], v[128:143]
    v_mfma_f32_32x32x16_bf16 v[144:159], v[52:55], v[60:63], v[144:159]
    s_waitcnt vmcnt(11) lgkmcnt(0)
    s_barrier
    v_mfma_f32_32x32x16_bf16 v[96:111], v[64:67], v[72:75], v[96:111]
    ds_read_b128 v[32:35], v10 offset:0
    ds_read_b64_tr_b16 v[40:41], v18 offset:0
    v_mfma_f32_32x32x16_bf16 v[112:127], v[64:67], v[76:79], v[112:127]
    ds_read_b64_tr_b16 v[42:43], v18 offset:1024
    ds_read_b64_tr_b16 v[44:45], v19 offset:0
    v_mfma_f32_32x32x16_bf16 v[128:143], v[68:71], v[72:75], v[128:143]
    ds_read_b64_tr_b16 v[46:47], v19 offset:1024
    ds_read_b128 v[36:39], v10 offset:4096
    v_mfma_f32_32x32x16_bf16 v[144:159], v[68:71], v[76:79], v[144:159]
    v_mfma_f32_32x32x16_bf16 v[96:111], v[80:83], v[88:91], v[96:111]
    ds_read_b128 v[48:51], v11 offset:0
    ds_read_b64_tr_b16 v[56:57], v18 offset:4096
    v_mfma_f32_32x32x16_bf16 v[112:127], v[80:83], v[92:95], v[112:127]
    ds_read_b64_tr_b16 v[58:59], v18 offset:5120
    ds_read_b64_tr_b16 v[60:61], v19 offset:4096
    v_mfma_f32_32x32x16_bf16 v[128:143], v[84:87], v[88:91], v[128:143]
    ds_read_b64_tr_b16 v[62:63], v19 offset:5120
    ds_read_b128 v[52:55], v11 offset:4096
    v_mfma_f32_32x32x16_bf16 v[144:159], v[84:87], v[92:95], v[144:159]
    s_waitcnt lgkmcnt(6)
    v_mfma_f32_32x32x16_bf16 v[96:111], v[32:35], v[40:43], v[96:111]
    ds_read_b128 v[64:67], v12 offset:0
    ds_read_b64_tr_b16 v[72:73], v18 offset:8192
    v_mfma_f32_32x32x16_bf16 v[112:127], v[32:35], v[44:47], v[112:127]
    ds_read_b64_tr_b16 v[74:75], v18 offset:9216
    ds_read_b64_tr_b16 v[76:77], v19 offset:8192
    v_mfma_f32_32x32x16_bf16 v[128:143], v[36:39], v[40:43], v[128:143]
    ds_read_b64_tr_b16 v[78:79], v19 offset:9216
    ds_read_b128 v[68:71], v12 offset:4096
    v_mfma_f32_32x32x16_bf16 v[144:159], v[36:39], v[44:47], v[144:159]
    s_waitcnt lgkmcnt(6)
    v_mfma_f32_32x32x16_bf16 v[96:111], v[48:51], v[56:59], v[96:111]
    ds_read_b128 v[80:83], v13 offset:0
    ds_read_b64_tr_b16 v[88:89], v18 offset:12288
    ds_read_b64_tr_b16 v[90:91], v18 offset:13312
    v_mfma_f32_32x32x16_bf16 v[112:127], v[48:51], v[60:63], v[112:127]
    ds_read_b64_tr_b16 v[92:93], v19 offset:12288
    ds_read_b64_tr_b16 v[94:95], v19 offset:13312
    ds_read_b128 v[84:87], v13 offset:4096
    v_mfma_f32_32x32x16_bf16 v[128:143], v[52:55], v[56:59], v[128:143]
    v_mfma_f32_32x32x16_bf16 v[144:159], v[52:55], v[60:63], v[144:159]
    s_waitcnt vmcnt(3) lgkmcnt(0)
    s_barrier
    v_mfma_f32_32x32x16_bf16 v[96:111], v[64:67], v[72:75], v[96:111]
    ds_read_b128 v[32:35], v10 offset:32768
    ds_read_b64_tr_b16 v[40:41], v18 offset:32768
    v_mfma_f32_32x32x16_bf16 v[112:127], v[64:67], v[76:79], v[112:127]
    ds_read_b64_tr_b16 v[42:43], v18 offset:33792
    ds_read_b64_tr_b16 v[44:45], v19 offset:32768
    v_mfma_f32_32x32x16_bf16 v[128:143], v[68:71], v[72:75], v[128:143]
    ds_read_b64_tr_b16 v[46:47], v19 offset:33792
    ds_read_b128 v[36:39], v10 offset:36864
    v_mfma_f32_32x32x16_bf16 v[144:159], v[68:71], v[76:79], v[144:159]
    v_mfma_f32_32x32x16_bf16 v[96:111], v[80:83], v[88:91], v[96:111]
    ds_read_b128 v[48:51], v11 offset:32768
    ds_read_b64_tr_b16 v[56:57], v18 offset:36864
    ds_read_b64_tr_b16 v[58:59], v18 offset:37888
    v_mfma_f32_32x32x16_bf16 v[112:127], v[80:83], v[92:95], v[112:127]
    ds_read_b64_tr_b16 v[60:61], v19 offset:36864
    ds_read_b64_tr_b16 v[62:63], v19 offset:37888
    ds_read_b128 v[52:55], v11 offset:36864
    v_mfma_f32_32x32x16_bf16 v[128:143], v[84:87], v[88:91], v[128:143]
    ds_read_b128 v[64:67], v12 offset:32768
    ds_read_b64_tr_b16 v[72:73], v18 offset:40960
    ds_read_b64_tr_b16 v[74:75], v18 offset:41984
    v_mfma_f32_32x32x16_bf16 v[144:159], v[84:87], v[92:95], v[144:159]
    ds_read_b64_tr_b16 v[76:77], v19 offset:40960
    ds_read_b64_tr_b16 v[78:79], v19 offset:41984
    ds_read_b128 v[68:71], v12 offset:36864
    s_waitcnt lgkmcnt(12)
    v_mfma_f32_32x32x16_bf16 v[96:111], v[32:35], v[40:43], v[96:111]
    ds_read_b128 v[80:83], v13 offset:32768
    ds_read_b64_tr_b16 v[88:89], v18 offset:45056
    ds_read_b64_tr_b16 v[90:91], v18 offset:46080
    v_mfma_f32_32x32x16_bf16 v[112:127], v[32:35], v[44:47], v[112:127]
    ds_read_b64_tr_b16 v[92:93], v19 offset:45056
    ds_read_b64_tr_b16 v[94:95], v19 offset:46080
    ds_read_b128 v[84:87], v13 offset:36864
    s_waitcnt lgkmcnt(12)
    v_mfma_f32_32x32x16_bf16 v[96:111], v[48:51], v[56:59], v[96:111]
    v_mfma_f32_32x32x16_bf16 v[112:127], v[48:51], v[60:63], v[112:127]
    s_waitcnt lgkmcnt(6)
    v_mfma_f32_32x32x16_bf16 v[96:111], v[64:67], v[72:75], v[96:111]
    v_mfma_f32_32x32x16_bf16 v[112:127], v[64:67], v[76:79], v[112:127]
    s_waitcnt lgkmcnt(1)
    v_mfma_f32_32x32x16_bf16 v[96:111], v[80:83], v[88:91], v[96:111]
    v_mfma_f32_32x32x16_bf16 v[112:127], v[80:83], v[92:95], v[112:127]
    s_waitcnt lgkmcnt(0)
    v_mfma_f32_32x32x16_bf16 v[128:143], v[36:39], v[40:43], v[128:143]
    v_mfma_f32_32x32x16_bf16 v[144:159], v[36:39], v[44:47], v[144:159]
    v_cvt_pk_bf16_f32 v96, v96, v97
    v_cvt_pk_bf16_f32 v97, v98, v99
    v_cvt_pk_bf16_f32 v98, v100, v101
    v_mfma_f32_32x32x16_bf16 v[128:143], v[52:55], v[56:59], v[128:143]
    v_cvt_pk_bf16_f32 v99, v102, v103
    buffer_store_dwordx4 v[96:99], v30, s[44:47], 0 offen offset:0 sc1
    v_cvt_pk_bf16_f32 v100, v104, v105
    v_mfma_f32_32x32x16_bf16 v[144:159], v[52:55], v[60:63], v[144:159]
    v_cvt_pk_bf16_f32 v101, v106, v107
    v_cvt_pk_bf16_f32 v102, v108, v109
    v_cvt_pk_bf16_f32 v103, v110, v111
    v_mfma_f32_32x32x16_bf16 v[128:143], v[68:71], v[72:75], v[128:143]
    buffer_store_dwordx4 v[100:103], v30, s[44:47], 0 offen offset:640 sc1
    v_cvt_pk_bf16_f32 v104, v112, v113
    v_cvt_pk_bf16_f32 v105, v114, v115
    v_mfma_f32_32x32x16_bf16 v[144:159], v[68:71], v[76:79], v[144:159]
    v_cvt_pk_bf16_f32 v106, v116, v117
    v_cvt_pk_bf16_f32 v107, v118, v119
    buffer_store_dwordx4 v[104:107], v31, s[44:47], 0 offen offset:0 sc1
    v_mfma_f32_32x32x16_bf16 v[128:143], v[84:87], v[88:91], v[128:143]
    v_cvt_pk_bf16_f32 v108, v120, v121
    v_cvt_pk_bf16_f32 v109, v122, v123
    v_cvt_pk_bf16_f32 v110, v124, v125
    v_mfma_f32_32x32x16_bf16 v[144:159], v[84:87], v[92:95], v[144:159]
    v_cvt_pk_bf16_f32 v111, v126, v127
    buffer_store_dwordx4 v[108:111], v31, s[44:47], 0 offen offset:640 sc1
    s_nop 7
    v_cvt_pk_bf16_f32 v128, v128, v129
    v_cvt_pk_bf16_f32 v129, v130, v131
    v_cvt_pk_bf16_f32 v130, v132, v133
    v_cvt_pk_bf16_f32 v131, v134, v135
    buffer_store_dwordx4 v[128:131], v30, s[44:47], 0 offen offset:1280 sc1
    v_cvt_pk_bf16_f32 v132, v136, v137
    v_cvt_pk_bf16_f32 v133, v138, v139
    v_cvt_pk_bf16_f32 v134, v140, v141
    v_cvt_pk_bf16_f32 v135, v142, v143
    buffer_store_dwordx4 v[132:135], v30, s[44:47], 0 offen offset:1920 sc1
    v_cvt_pk_bf16_f32 v136, v144, v145
    v_cvt_pk_bf16_f32 v137, v146, v147
    v_cvt_pk_bf16_f32 v138, v148, v149
    v_cvt_pk_bf16_f32 v139, v150, v151
    buffer_store_dwordx4 v[136:139], v31, s[44:47], 0 offen offset:1280 sc1
    v_cvt_pk_bf16_f32 v140, v152, v153
    v_cvt_pk_bf16_f32 v141, v154, v155
    v_cvt_pk_bf16_f32 v142, v156, v157
    v_cvt_pk_bf16_f32 v143, v158, v159
    buffer_store_dwordx4 v[140:143], v31, s[44:47], 0 offen offset:1920 sc1
    s_branch L_qkv_kernel_done
L_p1_aux:
    s_cmp_lt_u32 s3, 4
    s_cselect_b32 s4, 2, 0
    s_xor_b32 s3, s3, s4
    s_and_b32 s4, s3, 1
    s_lshl_b32 s5, s3, 13
    s_add_u32 s5, s5, 98304
    s_lshl1_add_u32 s6, s2, s4
    s_mul_i32 s7, s2, 10
    s_sub_u32 s7, s7, 1920
    s_lshr_b32 s34, s3, 2
    s_lshl1_add_u32 s4, s34, s4
    s_add_u32 s4, s4, s7
    s_add_u32 s7, s7, 10
    s_cmp_lt_u32 s2, 240
    s_cselect_b32 s4, s6, s4
    s_setprio 3
    v_and_b32 v1, 63, v0
    s_lshl_b32 s45, s3, 6
    s_and_b32 s45, s45, 128
    s_lshl_b32 s44, s4, 8
    s_add_u32 s44, s44, s45
    v_lshl_add_u32 v2, v1, 1, s44
    s_lshl_b32 s44, s4, 1
    v_mov_b32 v3, s44
    v_mov_b32 v4, 0
    v_mov_b32 v5, 0
    v_mov_b32 v6, 0
    v_mov_b32 v7, 0
    v_mov_b32 v8, 0
    v_mov_b32 v9, 0
    v_mov_b32 v10, 0
    v_mov_b32 v11, 0
    s_waitcnt lgkmcnt(0)
    global_load_short_d16_hi v10, v3, s[28:29] offset:0
    global_load_short_d16_hi v4, v2, s[16:17] offset:0
    global_load_short_d16_hi v5, v2, s[18:19] offset:0
    global_load_short_d16_hi v6, v2, s[20:21] offset:0
    global_load_short_d16_hi v7, v2, s[22:23] offset:0
    global_load_short_d16_hi v8, v2, s[24:25] offset:0
    global_load_short_d16_hi v9, v2, s[26:27] offset:0
    s_setprio 0
    s_cmp_ge_u32 s3, 6
    s_cbranch_scc1 L_kg_pf_7
    global_load_short_d16_hi v11, v3, s[30:31]
    s_branch L_kg_pfd_8
L_kg_pf_7:
    s_and_b32 s65, s2, 7
    s_lshl_b32 s65, s65, 2
    s_bfe_u32 s64, s2, 0x20003
    s_add_u32 s65, s65, s64
    s_lshr_b32 s66, s2, 6
    s_lshl2_add_u32 s66, s3, s66
    s_sub_u32 s66, s66, 22
    s_mov_b32 s39, 0x00020000
    s_bitcmp1_b32 s2, 5
    s_cbranch_scc1 L_pf_w
    s_mul_i32 s65, s65, 81920
    s_lshl_b32 s64, s66, 7
    v_mul_u32_u24 v12, 1280, v1
    s_mov_b32 s38, 2621440
    s_mov_b64 s[36:37], s[8:9]
    s_branch L_pf_go
L_pf_w:
    s_mul_i32 s65, s65, 7680
    s_mul_i32 s64, s66, 245760
    v_lshlrev_b32 v12, 7, v1
    s_mov_b32 s38, 2457600
    s_mov_b64 s[36:37], s[10:11]
L_pf_go:
    s_add_u32 s65, s65, s64
    buffer_load_dword v176, v12, s[36:39], s65 offen
L_kg_pfd_8:
    s_mov_b32 s42, 4608
    s_mov_b32 s43, 0x00020000
    v_and_b32 v13, 15, v1
    v_and_b32 v14, 3, v1
    v_bfe_u32 v15, v1, 3, 1
    v_lshl_add_u32 v14, v15, 2, v14
    v_lshrrev_b32 v15, 4, v1
    v_lshlrev_b32 v14, 1, v14
    v_xor_b32 v14, v14, v15
    v_lshlrev_b32 v14, 4, v14
    v_lshl_add_u32 v14, v13, 8, v14
    v_add_u32 v146, s5, v14
    v_xor_b32 v147, 64, v146
    v_xor_b32 v148, 128, v146
    v_xor_b32 v149, 192, v146
    v_lshl_add_u32 v138, v1, 2, s5
    v_xor_b32 v139, 32, v138
    v_xor_b32 v140, 64, v138
    v_xor_b32 v141, 96, v138
    v_xor_b32 v142, 128, v138
    v_xor_b32 v143, 160, v138
    v_xor_b32 v144, 192, v138
    v_xor_b32 v145, 224, v138
    v_lshl_add_u32 v150, v13, 4, s5
    v_lshl_add_u32 v152, v15, 8, v150
    v_lshl_add_u32 v153, v15, 9, v150
    v_lshrrev_b32 v154, 5, v1
    v_lshl_add_u32 v154, v154, 8, v150
    v_bfe_u32 v155, v1, 4, 1
    v_lshl_add_u32 v154, v155, 3, v154
    v_lshl_add_u32 v155, v1, 4, s5
    v_lshlrev_b32 v156, 4, v1
    v_add_u32 v153, 2488, v153
    s_cbranch_vccnz L_kg_g0_9
    global_load_short_d16_hi v164, v3, s[28:29] offset:8
    global_load_short_d16_hi v158, v2, s[16:17] offset:1024
    global_load_short_d16_hi v159, v2, s[18:19] offset:1024
    global_load_short_d16_hi v160, v2, s[20:21] offset:1024
    global_load_short_d16_hi v161, v2, s[22:23] offset:1024
    global_load_short_d16_hi v162, v2, s[24:25] offset:1024
    global_load_short_d16_hi v163, v2, s[26:27] offset:1024
    global_load_short_d16_hi v165, v3, s[30:31] offset:8
    s_cmp_ge_u32 s3, 4
    s_cbranch_scc1 L_kg_g1_10
    global_load_short_d16_hi v172, v3, s[28:29] offset:16
    global_load_short_d16_hi v166, v2, s[16:17] offset:2048
    global_load_short_d16_hi v167, v2, s[18:19] offset:2048
    global_load_short_d16_hi v168, v2, s[20:21] offset:2048
    global_load_short_d16_hi v169, v2, s[22:23] offset:2048
    global_load_short_d16_hi v170, v2, s[24:25] offset:2048
    global_load_short_d16_hi v171, v2, s[26:27] offset:2048
    global_load_short_d16_hi v173, v3, s[30:31] offset:16
    s_waitcnt vmcnt(17)
    s_branch L_kg_g0_9_x
L_kg_g1_10:
    s_waitcnt vmcnt(9)
    s_branch L_kg_g0_9_x
L_kg_g0_9:
    s_waitcnt vmcnt(1)
L_kg_g0_9_x:
    s_setprio 0
L_kg_top_11:
    v_mul_f32 v12, 0x3fb8aa3b, v10
    s_mov_b32 s44, 0x3fb8aa3b
    v_fma_f32 v13, v10, s44, -v12
    v_fmac_f32 v13, 0x32a57060, v10
    v_exp_f32 v12, v12
    v_mul_f32 v13, 0x3f317218, v13
    v_fmac_f32 v12, v12, v13
    v_cvt_pk_bf16_f32 v12, v12, v12
    v_lshlrev_b32 v18, 16, v12
    v_mul_f32 v12, v18, v4
    v_mul_f32 v13, v18, v5
    v_mul_f32 v14, v18, v6
    v_mul_f32 v15, v18, v7
    v_mul_f32 v12, 0x3fb8aa3b, v12
    v_mul_f32 v13, 0x3e22f983, v13
    v_pk_mul_f32 v[30:31], v[8:9], v[14:15] op_sel:[0,0] op_sel_hi:[0,1]
    v_mul_f32 v98, 0x41000000, v12
    v_mul_f32 v99, 0x41000000, v13
    v_mul_f32 v102, 0x43000000, v12
    v_mul_f32 v103, 0x43000000, v13
    v_mul_f32 v104, 0x44800000, v12
    v_mul_f32 v105, 0x44800000, v13
    v_pk_fma_f32 v[34:35], v[8:9], v[14:15], v[30:31] op_sel:[1,1,0] op_sel_hi:[1,0,1] neg_lo:[0,1,0]
    v_fract_f32 v99, v99
    v_exp_f32 v98, v98
    v_fract_f32 v101, v13
    v_exp_f32 v100, v12
    v_fract_f32 v103, v103
    v_exp_f32 v102, v102
    v_fract_f32 v105, v105
    v_exp_f32 v104, v104
    v_cos_f32 v22, v99
    v_sin_f32 v23, v99
    v_cos_f32 v20, v101
    v_sin_f32 v21, v101
    v_cos_f32 v24, v103
    v_sin_f32 v25, v103
    v_cos_f32 v26, v105
    v_sin_f32 v27, v105
    v_mov_b32 v50, 0x3f80
    v_pk_mul_f32 v[22:23], v[22:23], v[98:99] op_sel:[0,0] op_sel_hi:[1,0]
    v_pk_mul_f32 v[20:21], v[20:21], v[100:101] op_sel:[0,0] op_sel_hi:[1,0]
    v_pk_mul_f32 v[24:25], v[24:25], v[102:103] op_sel:[0,0] op_sel_hi:[1,0]
    v_pk_mul_f32 v[26:27], v[26:27], v[104:105] op_sel:[0,0] op_sel_hi:[1,0]
    v_cvt_pk_bf16_f32 v66, v34, v35
    v_cvt_pk_bf16_f32 v51, v22, -v23
    v_pk_mul_f32 v[30:31], v[22:23], v[22:23] op_sel:[0,0] op_sel_hi:[0,1]
    v_pk_mul_f32 v[32:33], v[34:35], v[20:21] op_sel:[0,0] op_sel_hi:[0,1]
    v_pk_fma_f32 v[28:29], v[22:23], v[22:23], v[30:31] op_sel:[1,1,0] op_sel_hi:[1,0,1] neg_lo:[0,1,0]
    v_pk_fma_f32 v[36:37], v[34:35], v[20:21], v[32:33] op_sel:[1,1,0] op_sel_hi:[1,0,1] neg_lo:[0,1,0]
    v_pk_mul_f32 v[30:31], v[28:29], v[22:23] op_sel:[0,0] op_sel_hi:[0,1]
    v_pk_mul_f32 v[32:33], v[36:37], v[20:21] op_sel:[0,0] op_sel_hi:[0,1]
    v_cvt_pk_bf16_f32 v52, v28, -v29
    v_cvt_pk_bf16_f32 v67, v36, v37
    v_pk_fma_f32 v[28:29], v[28:29], v[22:23], v[30:31] op_sel:[1,1,0] op_sel_hi:[1,0,1] neg_lo:[0,1,0]
    v_pk_fma_f32 v[38:39], v[36:37], v[20:21], v[32:33] op_sel:[1,1,0] op_sel_hi:[1,0,1] neg_lo:[0,1,0]
    v_pk_mul_f32 v[30:31], v[28:29], v[22:23] op_sel:[0,0] op_sel_hi:[0,1]
    v_pk_mul_f32 v[32:33], v[38:39], v[20:21] op_sel:[0,0] op_sel_hi:[0,1]
    v_cvt_pk_bf16_f32 v53, v28, -v29
    v_cvt_pk_bf16_f32 v68, v38, v39
    v_pk_fma_f32 v[28:29], v[28:29], v[22:23], v[30:31] op_sel:[1,1,0] op_sel_hi:[1,0,1] neg_lo:[0,1,0]
    v_pk_fma_f32 v[40:41], v[38:39], v[20:21], v[32:33] op_sel:[1,1,0] op_sel_hi:[1,0,1] neg_lo:[0,1,0]
    v_pk_mul_f32 v[30:31], v[28:29], v[22:23] op_sel:[0,0] op_sel_hi:[0,1]
    v_pk_mul_f32 v[32:33], v[40:41], v[20:21] op_sel:[0,0] op_sel_hi:[0,1]
    v_cvt_pk_bf16_f32 v54, v28, -v29
    v_cvt_pk_bf16_f32 v69, v40, v41
    v_pk_fma_f32 v[28:29], v[28:29], v[22:23], v[30:31] op_sel:[1,1,0] op_sel_hi:[1,0,1] neg_lo:[0,1,0]
    v_pk_fma_f32 v[42:43], v[40:41], v[20:21], v[32:33] op_sel:[1,1,0] op_sel_hi:[1,0,1] neg_lo:[0,1,0]
    ds_write2st64_b32 v138, v50, v54 offset0:16 offset1:20
    v_pk_mul_f32 v[30:31], v[28:29], v[22:23] op_sel:[0,0] op_sel_hi:[0,1]
    v_pk_mul_f32 v[32:33], v[42:43], v[20:21] op_sel:[0,0] op_sel_hi:[0,1]
    v_cvt_pk_bf16_f32 v55, v28, -v29
    v_cvt_pk_bf16_f32 v70, v42, v43
    v_pk_fma_f32 v[28:29], v[28:29], v[22:23], v[30:31] op_sel:[1,1,0] op_sel_hi:[1,0,1] neg_lo:[0,1,0]
    v_pk_fma_f32 v[44:45], v[42:43], v[20:21], v[32:33] op_sel:[1,1,0] op_sel_hi:[1,0,1] neg_lo:[0,1,0]
    ds_write2st64_b32 v139, v51, v55 offset0:17 offset1:21
    v_pk_mul_f32 v[30:31], v[28:29], v[22:23] op_sel:[0,0] op_sel_hi:[0,1]
    v_pk_mul_f32 v[32:33], v[44:45], v[20:21] op_sel:[0,0] op_sel_hi:[0,1]
    v_cvt_pk_bf16_f32 v56, v28, -v29
    v_cvt_pk_bf16_f32 v71, v44, v45
    v_pk_fma_f32 v[28:29], v[28:29], v[22:23], v[30:31] op_sel:[1,1,0] op_sel_hi:[1,0,1] neg_lo:[0,1,0]
    v_pk_fma_f32 v[46:47], v[44:45], v[20:21], v[32:33] op_sel:[1,1,0] op_sel_hi:[1,0,1] neg_lo:[0,1,0]
    ds_write2st64_b32 v140, v52, v56 offset0:18 offset1:22
    v_pk_mul_f32 v[30:31], v[28:29], v[22:23] op_sel:[0,0] op_sel_hi:[0,1]
    v_pk_mul_f32 v[32:33], v[46:47], v[20:21] op_sel:[0,0] op_sel_hi:[0,1]
    v_cvt_pk_bf16_f32 v57, v28, -v29
    v_cvt_pk_bf16_f32 v72, v46, v47
    v_pk_fma_f32 v[28:29], v[28:29], v[22:23], v[30:31] op_sel:[1,1,0] op_sel_hi:[1,0,1] neg_lo:[0,1,0]
    v_pk_fma_f32 v[48:49], v[46:47], v[20:21], v[32:33] op_sel:[1,1,0] op_sel_hi:[1,0,1] neg_lo:[0,1,0]
    ds_write2st64_b32 v141, v53, v57 offset0:19 offset1:23
    v_pk_mul_f32 v[30:31], v[28:29], v[22:23] op_sel:[0,0] op_sel_hi:[0,1]
    v_pk_mul_f32 v[32:33], v[26:27], v[34:35] op_sel:[0,0] op_sel_hi:[0,1]
    v_cvt_pk_bf16_f32 v58, v28, -v29
    v_cvt_pk_bf16_f32 v73, v48, v49
    v_pk_fma_f32 v[28:29], v[28:29], v[22:23], v[30:31] op_sel:[1,1,0] op_sel_hi:[1,0,1] neg_lo:[0,1,0]
    v_pk_fma_f32 v[26:27], v[26:27], v[34:35], v[32:33] op_sel:[1,1,0] op_sel_hi:[1,0,1] neg_lo:[0,1,0]
    ds_write2st64_b32 v138, v66, v70 offset0:0 offset1:4
    v_pk_mul_f32 v[30:31], v[28:29], v[22:23] op_sel:[0,0] op_sel_hi:[0,1]
    v_pk_mul_f32 v[32:33], v[34:35], v[24:25] op_sel:[0,0] op_sel_hi:[0,1]
    v_cvt_pk_bf16_f32 v59, v28, -v29
    v_cvt_pk_bf16_f32 v84, v26, v27
    v_pk_fma_f32 v[28:29], v[28:29], v[22:23], v[30:31] op_sel:[1,1,0] op_sel_hi:[1,0,1] neg_lo:[0,1,0]
    v_pk_fma_f32 v[34:35], v[34:35], v[24:25], v[32:33] op_sel:[1,1,0] op_sel_hi:[1,0,1] neg_lo:[0,1,0]
    ds_write2st64_b32 v139, v67, v71 offset0:1 offset1:5
    v_pk_mul_f32 v[30:31], v[28:29], v[22:23] op_sel:[0,0] op_sel_hi:[0,1]
    v_pk_mul_f32 v[32:33], v[42:43], v[24:25] op_sel:[0,0] op_sel_hi:[0,1]
    v_cvt_pk_bf16_f32 v60, v28, -v29
    v_cvt_pk_bf16_f32 v74, v34, v35
    v_pk_fma_f32 v[28:29], v[28:29], v[22:23], v[30:31] op_sel:[1,1,0] op_sel_hi:[1,0,1] neg_lo:[0,1,0]
    v_pk_fma_f32 v[42:43], v[42:43], v[24:25], v[32:33] op_sel:[1,1,0] op_sel_hi:[1,0,1] neg_lo:[0,1,0]
    ds_write2st64_b32 v140, v68, v72 offset0:2 offset1:6
    v_pk_mul_f32 v[30:31], v[28:29], v[22:23] op_sel:[0,0] op_sel_hi:[0,1]
    v_pk_mul_f32 v[32:33], v[36:37], v[24:25] op_sel:[0,0] op_sel_hi:[0,1]
    v_cvt_pk_bf16_f32 v61, v28, -v29
    v_cvt_pk_bf16_f32 v78, v42, v43
    v_pk_fma_f32 v[28:29], v[28:29], v[22:23], v[30:31] op_sel:[1,1,0] op_sel_hi:[1,0,1] neg_lo:[0,1,0]
    v_pk_fma_f32 v[36:37], v[36:37], v[24:25], v[32:33] op_sel:[1,1,0] op_sel_hi:[1,0,1] neg_lo:[0,1,0]
    ds_write2st64_b32 v141, v69, v73 offset0:3 offset1:7
    v_pk_mul_f32 v[30:31], v[28:29], v[22:23] op_sel:[0,0] op_sel_hi:[0,1]
    v_pk_mul_f32 v[32:33], v[44:45], v[24:25] op_sel:[0,0] op_sel_hi:[0,1]
    v_cvt_pk_bf16_f32 v62, v28, -v29
    v_cvt_pk_bf16_f32 v75, v36, v37
    v_pk_fma_f32 v[28:29], v[28:29], v[22:23], v[30:31] op_sel:[1,1,0] op_sel_hi:[1,0,1] neg_lo:[0,1,0]
    v_pk_fma_f32 v[44:45], v[44:45], v[24:25], v[32:33] op_sel:[1,1,0] op_sel_hi:[1,0,1] neg_lo:[0,1,0]
    ds_write2st64_b32 v142, v58, v62 offset0:24 offset1:28
    v_pk_mul_f32 v[30:31], v[28:29], v[22:23] op_sel:[0,0] op_sel_hi:[0,1]
    v_pk_mul_f32 v[32:33], v[38:39], v[24:25] op_sel:[0,0] op_sel_hi:[0,1]
    v_cvt_pk_bf16_f32 v63, v28, -v29
    v_cvt_pk_bf16_f32 v79, v44, v45
    v_pk_fma_f32 v[28:29], v[28:29], v[22:23], v[30:31] op_sel:[1,1,0] op_sel_hi:[1,0,1] neg_lo:[0,1,0]
    v_pk_fma_f32 v[38:39], v[38:39], v[24:25], v[32:33] op_sel:[1,1,0] op_sel_hi:[1,0,1] neg_lo:[0,1,0]
    ds_write2st64_b32 v143, v59, v63 offset0:25 offset1:29
    v_pk_mul_f32 v[30:31], v[28:29], v[22:23] op_sel:[0,0] op_sel_hi:[0,1]
    v_pk_mul_f32 v[32:33], v[46:47], v[24:25] op_sel:[0,0] op_sel_hi:[0,1]
    v_cvt_pk_bf16_f32 v64, v28, -v29
    v_cvt_pk_bf16_f32 v76, v38, v39
    v_pk_fma_f32 v[28:29], v[28:29], v[22:23], v[30:31] op_sel:[1,1,0] op_sel_hi:[1,0,1] neg_lo:[0,1,0]
    v_pk_fma_f32 v[46:47], v[46:47], v[24:25], v[32:33] op_sel:[1,1,0] op_sel_hi:[1,0,1] neg_lo:[0,1,0]
    ds_write2st64_b32 v144, v60, v64 offset0:26 offset1:30
    v_pk_mul_f32 v[30:31], v[40:41], v[24:25] op_sel:[0,0] op_sel_hi:[0,1]
    v_pk_mul_f32 v[32:33], v[48:49], v[24:25] op_sel:[0,0] op_sel_hi:[0,1]
    v_cvt_pk_bf16_f32 v65, v28, -v29
    v_cvt_pk_bf16_f32 v80, v46, v47
    v_pk_fma_f32 v[40:41], v[40:41], v[24:25], v[30:31] op_sel:[1,1,0] op_sel_hi:[1,0,1] neg_lo:[0,1,0]
    v_pk_fma_f32 v[48:49], v[48:49], v[24:25], v[32:33] op_sel:[1,1,0] op_sel_hi:[1,0,1] neg_lo:[0,1,0]
    ds_write2st64_b32 v145, v61, v65 offset0:27 offset1:31
    ds_read_b128 v[50:53], v146 offset:4096
    ds_read_b128 v[54:57], v147 offset:4096
    ds_read_b128 v[58:61], v148 offset:4096
    ds_read_b128 v[62:65], v149 offset:4096
    v_pk_mul_f32 v[30:31], v[26:27], v[24:25] op_sel:[0,0] op_sel_hi:[0,1]
    v_pk_mul_f32 v[32:33], v[34:35], v[24:25] op_sel:[0,0] op_sel_hi:[0,1]
    v_cvt_pk_bf16_f32 v77, v40, v41
    v_cvt_pk_bf16_f32 v81, v48, v49
    v_pk_fma_f32 v[26:27], v[26:27], v[24:25], v[30:31] op_sel:[1,1,0] op_sel_hi:[1,0,1] neg_lo:[0,1,0]
    v_pk_fma_f32 v[34:35], v[34:35], v[24:25], v[32:33] op_sel:[1,1,0] op_sel_hi:[1,0,1] neg_lo:[0,1,0]
    ds_write2st64_b32 v142, v74, v78 offset0:8 offset1:12
    v_pk_mul_f32 v[30:31], v[26:27], v[24:25] op_sel:[0,0] op_sel_hi:[0,1]
    v_pk_mul_f32 v[32:33], v[38:39], v[24:25] op_sel:[0,0] op_sel_hi:[0,1]
    v_cvt_pk_bf16_f32 v85, v26, v27
    v_cvt_pk_bf16_f32 v98, v34, v35
    v_pk_fma_f32 v[26:27], v[26:27], v[24:25], v[30:31] op_sel:[1,1,0] op_sel_hi:[1,0,1] neg_lo:[0,1,0]
    v_pk_fma_f32 v[38:39], v[38:39], v[24:25], v[32:33] op_sel:[1,1,0] op_sel_hi:[1,0,1] neg_lo:[0,1,0]
    ds_write2st64_b32 v143, v75, v79 offset0:9 offset1:13
    v_pk_mul_f32 v[30:31], v[26:27], v[24:25] op_sel:[0,0] op_sel_hi:[0,1]
    v_pk_mul_f32 v[32:33], v[42:43], v[24:25] op_sel:[0,0] op_sel_hi:[0,1]
    v_cvt_pk_bf16_f32 v88, v26, v27
    v_cvt_pk_bf16_f32 v99, v38, v39
    v_pk_fma_f32 v[26:27], v[26:27], v[24:25], v[30:31] op_sel:[1,1,0] op_sel_hi:[1,0,1] neg_lo:[0,1,0]
    v_pk_fma_f32 v[42:43], v[42:43], v[24:25], v[32:33] op_sel:[1,1,0] op_sel_hi:[1,0,1] neg_lo:[0,1,0]
    ds_write2st64_b32 v144, v76, v80 offset0:10 offset1:14
    v_pk_mul_f32 v[30:31], v[26:27], v[24:25] op_sel:[0,0] op_sel_hi:[0,1]
    v_pk_mul_f32 v[32:33], v[46:47], v[24:25] op_sel:[0,0] op_sel_hi:[0,1]
    v_cvt_pk_bf16_f32 v89, v26, v27
    v_cvt_pk_bf16_f32 v100, v42, v43
    v_pk_fma_f32 v[26:27], v[26:27], v[24:25], v[30:31] op_sel:[1,1,0] op_sel_hi:[1,0,1] neg_lo:[0,1,0]
    v_pk_fma_f32 v[46:47], v[46:47], v[24:25], v[32:33] op_sel:[1,1,0] op_sel_hi:[1,0,1] neg_lo:[0,1,0]
    ds_write2st64_b32 v145, v77, v81 offset0:11 offset1:15
    ds_read_b128 v[66:69], v146 offset:0
    ds_read_b128 v[70:73], v147 offset:0
    ds_read_b128 v[74:77], v148 offset:0
    ds_read_b128 v[78:81], v149 offset:0
    v_pk_mul_f32 v[30:31], v[26:27], v[24:25] op_sel:[0,0] op_sel_hi:[0,1]
    v_pk_mul_f32 v[32:33], v[34:35], v[24:25] op_sel:[0,0] op_sel_hi:[0,1]
    v_cvt_pk_bf16_f32 v92, v26, v27
    v_cvt_pk_bf16_f32 v101, v46, v47
    v_pk_fma_f32 v[26:27], v[26:27], v[24:25], v[30:31] op_sel:[1,1,0] op_sel_hi:[1,0,1] neg_lo:[0,1,0]
    v_pk_fma_f32 v[34:35], v[34:35], v[24:25], v[32:33] op_sel:[1,1,0] op_sel_hi:[1,0,1] neg_lo:[0,1,0]
    ds_write2st64_b32 v140, v84, v88 offset0:2 offset1:6
    v_pk_mul_f32 v[30:31], v[26:27], v[24:25] op_sel:[0,0] op_sel_hi:[0,1]
    v_pk_mul_f32 v[32:33], v[38:39], v[24:25] op_sel:[0,0] op_sel_hi:[0,1]
    v_cvt_pk_bf16_f32 v93, v26, v27
    v_cvt_pk_bf16_f32 v102, v34, v35
    v_pk_fma_f32 v[26:27], v[26:27], v[24:25], v[30:31] op_sel:[1,1,0] op_sel_hi:[1,0,1] neg_lo:[0,1,0]
    v_pk_fma_f32 v[38:39], v[38:39], v[24:25], v[32:33] op_sel:[1,1,0] op_sel_hi:[1,0,1] neg_lo:[0,1,0]
    ds_write2st64_b32 v138, v98, v102 offset0:16 offset1:20
    s_waitcnt lgkmcnt(2)
    v_mfma_f32_16x16x32_bf16 v[114:117], v[66:69], v[50:53], 0
    v_mfma_f32_16x16x32_bf16 v[114:117], v[70:73], v[54:57], v[114:117]
    v_mfma_f32_16x16x32_bf16 v[114:117], v[74:77], v[58:61], v[114:117]
    v_mfma_f32_16x16x32_bf16 v[114:117], v[78:81], v[62:65], v[114:117]
    v_pk_mul_f32 v[30:31], v[26:27], v[24:25] op_sel:[0,0] op_sel_hi:[0,1]
    v_pk_mul_f32 v[32:33], v[42:43], v[24:25] op_sel:[0,0] op_sel_hi:[0,1]
    v_cvt_pk_bf16_f32 v96, v26, v27
    v_cvt_pk_bf16_f32 v103, v38, v39
    v_pk_fma_f32 v[26:27], v[26:27], v[24:25], v[30:31] op_sel:[1,1,0] op_sel_hi:[1,0,1] neg_lo:[0,1,0]
    v_pk_fma_f32 v[42:43], v[42:43], v[24:25], v[32:33] op_sel:[1,1,0] op_sel_hi:[1,0,1] neg_lo:[0,1,0]
    ds_write2st64_b32 v139, v99, v103 offset0:17 offset1:21
    v_pk_mul_f32 v[30:31], v[26:27], v[24:25] op_sel:[0,0] op_sel_hi:[0,1]
    v_pk_mul_f32 v[32:33], v[46:47], v[24:25] op_sel:[0,0] op_sel_hi:[0,1]
    v_cvt_pk_bf16_f32 v97, v26, v27
    v_cvt_pk_bf16_f32 v104, v42, v43
    v_pk_fma_f32 v[26:27], v[26:27], v[24:25], v[30:31] op_sel:[1,1,0] op_sel_hi:[1,0,1] neg_lo:[0,1,0]
    v_pk_fma_f32 v[46:47], v[46:47], v[24:25], v[32:33] op_sel:[1,1,0] op_sel_hi:[1,0,1] neg_lo:[0,1,0]
    ds_write2st64_b32 v140, v100, v104 offset0:18 offset1:22
    v_pk_mul_f32 v[30:31], v[34:35], v[24:25] op_sel:[0,0] op_sel_hi:[0,1]
    v_pk_mul_f32 v[32:33], v[42:43], v[24:25] op_sel:[0,0] op_sel_hi:[0,1]
    v_cvt_pk_bf16_f32 v106, v26, v27
    v_cvt_pk_bf16_f32 v105, v46, v47
    v_pk_fma_f32 v[34:35], v[34:35], v[24:25], v[30:31] op_sel:[1,1,0] op_sel_hi:[1,0,1] neg_lo:[0,1,0]
    v_pk_fma_f32 v[42:43], v[42:43], v[24:25], v[32:33] op_sel:[1,1,0] op_sel_hi:[1,0,1] neg_lo:[0,1,0]
    ds_write2st64_b32 v141, v101, v105 offset0:19 offset1:23
    v_pk_mul_f32 v[30:31], v[34:35], v[24:25] op_sel:[0,0] op_sel_hi:[0,1]
    v_pk_mul_f32 v[32:33], v[42:43], v[24:25] op_sel:[0,0] op_sel_hi:[0,1]
    v_cvt_pk_bf16_f32 v82, v34, v35
    v_cvt_pk_bf16_f32 v83, v42, v43
    v_pk_fma_f32 v[34:35], v[34:35], v[24:25], v[30:31] op_sel:[1,1,0] op_sel_hi:[1,0,1] neg_lo:[0,1,0]
    v_pk_fma_f32 v[42:43], v[42:43], v[24:25], v[32:33] op_sel:[1,1,0] op_sel_hi:[1,0,1] neg_lo:[0,1,0]
    ds_write2st64_b32 v142, v106, v106 offset0:24 offset1:28
    ds_read_b128 v[98:101], v146 offset:4096
    ds_read_b128 v[102:105], v147 offset:4096
    ds_read_b128 v[106:109], v148 offset:4096
    ds_read_b128 v[110:113], v149 offset:4096
    v_pk_mul_f32 v[30:31], v[34:35], v[24:25] op_sel:[0,0] op_sel_hi:[0,1]
    v_pk_mul_f32 v[32:33], v[42:43], v[24:25] op_sel:[0,0] op_sel_hi:[0,1]
    v_cvt_pk_bf16_f32 v86, v34, v35
    v_cvt_pk_bf16_f32 v87, v42, v43
    v_pk_fma_f32 v[34:35], v[34:35], v[24:25], v[30:31] op_sel:[1,1,0] op_sel_hi:[1,0,1] neg_lo:[0,1,0]
    v_pk_fma_f32 v[42:43], v[42:43], v[24:25], v[32:33] op_sel:[1,1,0] op_sel_hi:[1,0,1] neg_lo:[0,1,0]
    ds_write2st64_b32 v138, v82, v86 offset0:0 offset1:4
    v_pk_mul_f32 v[30:31], v[34:35], v[24:25] op_sel:[0,0] op_sel_hi:[0,1]
    v_pk_mul_f32 v[32:33], v[42:43], v[24:25] op_sel:[0,0] op_sel_hi:[0,1]
    v_cvt_pk_bf16_f32 v90, v34, v35
    v_cvt_pk_bf16_f32 v91, v42, v43
    v_pk_fma_f32 v[34:35], v[34:35], v[24:25], v[30:31] op_sel:[1,1,0] op_sel_hi:[1,0,1] neg_lo:[0,1,0]
    v_pk_fma_f32 v[42:43], v[42:43], v[24:25], v[32:33] op_sel:[1,1,0] op_sel_hi:[1,0,1] neg_lo:[0,1,0]
    ds_write2st64_b32 v139, v83, v87 offset0:1 offset1:5
    s_waitcnt lgkmcnt(2)
    v_mfma_f32_16x16x32_bf16 v[122:125], v[98:101], v[50:53], 0
    v_mfma_f32_16x16x32_bf16 v[122:125], v[102:105], v[54:57], v[122:125]
    v_mfma_f32_16x16x32_bf16 v[122:125], v[106:109], v[58:61], v[122:125]
    v_mfma_f32_16x16x32_bf16 v[122:125], v[110:113], v[62:65], v[122:125]
    s_nop 0
    v_cvt_pk_bf16_f32 v94, v34, v35
    v_cvt_pk_bf16_f32 v95, v42, v43
    ds_write2st64_b32 v141, v85, v89 offset0:3 offset1:7
    ds_write2st64_b32 v142, v90, v94 offset0:8 offset1:12
    ds_write2st64_b32 v143, v91, v95 offset0:9 offset1:13
    ds_write2st64_b32 v144, v92, v96 offset0:10 offset1:14
    ds_write2st64_b32 v145, v93, v97 offset0:11 offset1:15
    ds_read_b128 v[82:85], v146 offset:0
    ds_read_b128 v[86:89], v147 offset:0
    ds_read_b128 v[90:93], v148 offset:0
    ds_read_b128 v[94:97], v149 offset:0
    v_mov_b32 v12, 0
    v_mov_b32 v13, 0
    v_mov_b32 v14, 0
    v_mov_b32 v15, 0
    s_mov_b64 exec, 0x0fffffff
    ds_write_b128 v155, v[12:15]
    s_mov_b64 exec, 0xf
    ds_write_b128 v155, v[12:15] offset:4544
    s_mov_b64 exec, -1
    s_waitcnt lgkmcnt(2)
    v_mfma_f32_16x16x32_bf16 v[118:121], v[82:85], v[50:53], 0
    v_mfma_f32_16x16x32_bf16 v[118:121], v[86:89], v[54:57], v[118:121]
    v_mfma_f32_16x16x32_bf16 v[118:121], v[90:93], v[58:61], v[118:121]
    v_mfma_f32_16x16x32_bf16 v[118:121], v[94:97], v[62:65], v[118:121]
    s_mul_i32 s44, s4, 4608
    s_add_u32 s44, s44, 10493952
    s_add_u32 s40, s32, s44
    s_addc_u32 s41, s33, 0
    s_add_u32 s4, s4, 4
    s_bitcmp0_b32 s3, 1
    s_cbranch_scc1 L_kg_a_12
    ds_write_b128 v155, v[114:117] offset:0
    ds_write_b128 v155, v[122:125] offset:2048
    ds_write_b128 v155, v[118:121] offset:1024
    s_waitcnt lgkmcnt(0)
    s_barrier
    s_cbranch_vccnz L_p1_bd
    s_cmp_ge_u32 s4, s7
    s_barrier
    s_cbranch_scc1 L_p1_bd
    s_waitcnt vmcnt(0)
    v_and_b32 v4, 0xffff0000, v158
    v_mov_b32 v158, v166
    v_and_b32 v5, 0xffff0000, v159
    v_mov_b32 v159, v167
    v_and_b32 v6, 0xffff0000, v160
    v_mov_b32 v160, v168
    v_and_b32 v7, 0xffff0000, v161
    v_mov_b32 v161, v169
    v_and_b32 v8, 0xffff0000, v162
    v_mov_b32 v162, v170
    v_and_b32 v9, 0xffff0000, v163
    v_mov_b32 v163, v171
    v_and_b32 v10, 0xffff0000, v164
    v_mov_b32 v164, v172
    v_and_b32 v11, 0xffff0000, v165
    v_mov_b32 v165, v173
    s_branch L_kg_top_11
L_kg_a_12:
    s_mov_b32 s46, 0x55555555
    s_mov_b32 s47, 0x55555555
    s_waitcnt vmcnt(0)
    s_mov_b64 exec, 1
    v_add_f32 v114, v114, v11
    s_mov_b64 exec, -1
    s_barrier
    s_setprio 0
    ds_read_b128 v[130:133], v155 offset:17408
    ds_read_b128 v[134:137], v155 offset:18432
    ds_read_b128 v[126:129], v155 offset:16384
    s_cbranch_vccnz L_kg_n1_13
    s_waitcnt lgkmcnt(0)
    s_barrier
L_kg_n1_13:
    s_waitcnt lgkmcnt(2)
    v_add_f32 v118, v118, v130
    v_add_f32 v119, v119, v131
    v_add_f32 v120, v120, v132
    v_add_f32 v121, v121, v133
    v_cvt_pk_bf16_f32 v20, v120, v120
    v_cvt_pk_bf16_f32 v21, v120, v120
    v_cvt_pk_bf16_f32 v22, v121, v121
    v_cvt_pk_bf16_f32 v23, v121, v121
    v_cvt_pk_bf16_f32 v24, v118, v118
    v_cvt_pk_bf16_f32 v25, v118, v119
    v_cvt_pk_bf16_f32 v26, v119, v119
    s_waitcnt lgkmcnt(0)
    ds_write2_b64 v153, v[20:21], v[20:21] offset0:0 offset1:1
    ds_write2_b64 v153, v[22:23], v[22:23] offset0:32 offset1:33
    v_add_f32 v122, v122, v134
    v_add_f32 v123, v123, v135
    v_add_f32 v124, v124, v136
    v_add_f32 v125, v125, v137
    s_mov_b64 exec, s[46:47]
    ds_write_b16 v153, v20 offset:16
    ds_write_b16 v153, v22 offset:272
    s_mov_b64 exec, -1
    v_add_f32 v114, v114, v126
    v_add_f32 v115, v115, v127
    v_add_f32 v116, v116, v128
    v_add_f32 v117, v117, v129
    ds_write_b32 v152, v24 offset:1468
    v_cvt_pk_bf16_f32 v28, v122, v122
    v_cvt_pk_bf16_f32 v29, v123, v124
    v_cvt_pk_bf16_f32 v30, v124, v124
    v_cvt_pk_bf16_f32 v31, v125, v125
    ds_write_b96 v152, v[24:26] offset:1472
    v_cvt_pk_bf16_f32 v32, v114, v115
    v_cvt_pk_bf16_f32 v33, v116, v117
    s_mov_b32 exec_hi, 0
    ds_write_b16 v152, v28 offset:958
    ds_write_b96 v152, v[28:30] offset:960
    ds_write_b16 v152, v31 offset:972
    s_mov_b32 exec_lo, 0
    s_mov_b32 exec_hi, 1
    ds_write_b32 v150, v28 offset:4536
    ds_write_b32 v150, v28 offset:4540
    s_mov_b64 exec, -1
    ds_write_b64 v154, v[32:33] offset:448
    ds_read_b128 v[50:53], v155 offset:0
    ds_read_b128 v[54:57], v155 offset:1024
    ds_read_b128 v[58:61], v155 offset:2048
    ds_read_b128 v[62:65], v155 offset:3072
    ds_read_b128 v[66:69], v155 offset:4096
    s_movk_i32 s44, 4096
    s_waitcnt lgkmcnt(4)
    buffer_store_dwordx4 v[50:53], v156, s[40:43], 0 offen offset:0 sc1
    s_waitcnt lgkmcnt(3)
    buffer_store_dwordx4 v[54:57], v156, s[40:43], 0 offen offset:1024 sc1
    s_waitcnt lgkmcnt(2)
    buffer_store_dwordx4 v[58:61], v156, s[40:43], 0 offen offset:2048 sc1
    s_waitcnt lgkmcnt(1)
    buffer_store_dwordx4 v[62:65], v156, s[40:43], 0 offen offset:3072 sc1
    s_waitcnt lgkmcnt(0)
    buffer_store_dwordx4 v[66:69], v156, s[40:43], s44 offen sc1
    s_cbranch_vccnz L_kg_g_14
    s_cmp_ge_u32 s4, s7
    s_cbranch_scc1 L_p1_ad
    v_and_b32 v4, 0xffff0000, v158
    v_mov_b32 v158, v166
    v_and_b32 v5, 0xffff0000, v159
    v_mov_b32 v159, v167
    v_and_b32 v6, 0xffff0000, v160
    v_mov_b32 v160, v168
    v_and_b32 v7, 0xffff0000, v161
    v_mov_b32 v161, v169
    v_and_b32 v8, 0xffff0000, v162
    v_mov_b32 v162, v170
    v_and_b32 v9, 0xffff0000, v163
    v_mov_b32 v163, v171
    v_and_b32 v10, 0xffff0000, v164
    v_mov_b32 v164, v172
    v_and_b32 v11, 0xffff0000, v165
    v_mov_b32 v165, v173
    s_branch L_kg_top_11
L_kg_g_14:
    s_barrier
    s_barrier
    s_barrier
    s_barrier
    s_barrier
    s_barrier
    s_barrier
    s_barrier
    s_barrier
    s_barrier
    s_branch L_p1_ad
L_p1_bd:
    s_cmp_lg_u32 s2, 0
    s_cbranch_scc1 L_p1_nz
    s_add_u32 s36, s32, 19505152
    s_addc_u32 s37, s33, 0
    s_mov_b32 s38, 2048
    s_mov_b32 s39, 0x00020000
    s_mov_b64 exec, 0xffff
    v_mbcnt_lo_u32_b32 v2, -1, 0
    v_mov_b32 v3, 0
    v_lshlrev_b32 v2, 7, v2
    buffer_store_dword v3, v2, s[36:39], 0 offen
L_p1_nz:
    s_cbranch_vccnz L_qkv_kernel_done_x
L_p1_ad:
L_qkv_kernel_done:
L_qkv_kernel_done_x:
    s_endpgm
L_qkv_kernel_end:
.globl attn_kernel
.p2align 8
.type attn_kernel,@function
attn_kernel:
    s_cmp_ge_u32 s2, 256
    s_cbranch_scc1 L_attn_kernel_done_x
    s_getpc_b64 s[96:97]
L_attn_kernel_pc:
    v_lshlrev_b32 v1, 6, v0
    v_min_u32 v1, L_attn_kernel_end-L_attn_kernel_pc-4, v1
    global_load_dword v160, v1, s[96:97]
    s_load_dwordx2 s[4:5], s[0:1], 112
    s_load_dwordx2 s[6:7], s[0:1], 16
    s_load_dwordx2 s[44:45], s[0:1], 96
    v_lshrrev_b32 v2, 6, v0
    v_and_b32 v1, 63, v0
    v_readfirstlane_b32 s3, v2
    s_and_b32 s16, s2, 7
    s_lshl_b32 s16, s16, 2
    s_bfe_u32 s17, s2, 0x20003
    s_add_u32 s16, s16, s17
    s_movk_i32 s28, 102
    s_cmp_lt_u32 s3, 8
    s_cbranch_scc1 L_p2_attn
    s_setprio 3
    s_sub_u32 s17, s3, 8
    v_lshlrev_b32 v2, 4, v1
    s_mul_i32 s23, s16, 163840
    s_lshl_b32 s19, s17, 12
    s_add_u32 s22, s23, s19
    s_mov_b32 m0, s19
    s_mov_b32 s10, 19507200
    s_mov_b32 s11, 0x00020000
    s_and_b32 s24, s2, 7
    s_lshl_b32 s24, s24, 3
    s_lshr_b32 s20, s2, 5
    s_add_u32 s24, s24, s20
    s_mul_i32 s24, s24, 10
    s_bfe_u32 s20, s2, 0x20003
    s_lshl_b32 s21, s20, 1
    s_add_u32 s21, s21, 2
    s_cmp_eq_u32 s20, 0
    s_cselect_b32 s21, 0, s21
    s_cselect_b32 s31, 2, -1
    s_add_u32 s24, s24, s21
    s_cmp_lt_u32 s20, 2
    s_cselect_b32 s25, 3, 2
    s_mov_b32 s14, 819200
    s_mov_b32 s15, 0x00020000
    s_waitcnt lgkmcnt(0)
    s_mov_b64 s[8:9], s[4:5]
    s_mov_b64 s[12:13], s[6:7]
    buffer_load_dwordx4 v2, s[8:11], s22 offen offset:0 lds
    buffer_load_dwordx4 v2, s[8:11], s22 offen offset:1024 lds
    buffer_load_dwordx4 v2, s[8:11], s22 offen offset:2048 lds
    buffer_load_dwordx4 v2, s[8:11], s22 offen offset:3072 lds
    s_add_u32 m0, m0, 16384
    s_add_u32 s22, s22, 16384
    buffer_load_dwordx4 v2, s[8:11], s22 offen offset:0 lds
    buffer_load_dwordx4 v2, s[8:11], s22 offen offset:1024 lds
    buffer_load_dwordx4 v2, s[8:11], s22 offen offset:2048 lds
    buffer_load_dwordx4 v2, s[8:11], s22 offen offset:3072 lds
    s_add_u32 m0, m0, 16384
    s_add_u32 s22, s22, 16384
    buffer_load_dwordx4 v2, s[8:11], s22 offen offset:0 lds
    buffer_load_dwordx4 v2, s[8:11], s22 offen offset:1024 lds
    buffer_load_dwordx4 v2, s[8:11], s22 offen offset:2048 lds
    buffer_load_dwordx4 v2, s[8:11], s22 offen offset:3072 lds
    s_add_u32 m0, m0, 16384
    s_add_u32 s22, s22, 16384
    buffer_load_dwordx4 v2, s[8:11], s22 offen offset:0 lds
    buffer_load_dwordx4 v2, s[8:11], s22 offen offset:1024 lds
    buffer_load_dwordx4 v2, s[8:11], s22 offen offset:2048 lds
    buffer_load_dwordx4 v2, s[8:11], s22 offen offset:3072 lds
    s_add_u32 m0, m0, 16384
    s_add_u32 s22, s22, 16384
    v_mov_b32 v120, 0
    v_mov_b32 v121, 0
    v_mov_b32 v122, 0
    v_mov_b32 v123, 0
    v_mul_u32_u24 v11, 528, v1
    s_mov_b64 exec, 0xf
    v_add_u32 v11, 149504, v11
    ds_write_b128 v11, v[120:123]
    ds_write_b128 v11, v[120:123] offset:16
    s_mov_b64 exec, -1
    v_mov_b32 v10, 151088
    v_mov_b32 v144, 1
    v_lshlrev_b32 v15, 7, v1
    v_lshlrev_b32 v124, 7, v1
    s_lshl_b32 s21, s17, 10
    s_mov_b32 s19, s24
    s_mul_i32 s36, s19, 4608
    s_add_u32 s36, s36, 10493952
    s_lshr_b32 s20, s19, 3
    s_lshl_b32 s20, s20, 2
    s_add_u32 s20, s20, s17
    s_lshl_b32 s20, s20, 9
    s_and_b32 s19, s19, 7
    s_add_u32 s20, s20, s19
    s_lshl_b32 s20, s20, 4
    s_add_u32 s40, s20, 14262272
    s_add_u32 s19, s24, 1
    s_mul_i32 s37, s19, 4608
    s_add_u32 s37, s37, 10493952
    s_lshr_b32 s20, s19, 3
    s_lshl_b32 s20, s20, 2
    s_add_u32 s20, s20, s17
    s_lshl_b32 s20, s20, 9
    s_and_b32 s19, s19, 7
    s_add_u32 s20, s20, s19
    s_lshl_b32 s20, s20, 4
    s_add_u32 s41, s20, 14262272
    s_add_u32 s19, s24, s31
    s_mul_i32 s38, s19, 4608
    s_add_u32 s38, s38, 10493952
    s_lshr_b32 s20, s19, 3
    s_lshl_b32 s20, s20, 2
    s_add_u32 s20, s20, s17
    s_lshl_b32 s20, s20, 9
    s_and_b32 s19, s19, 7
    s_add_u32 s20, s20, s19
    s_lshl_b32 s20, s20, 4
    s_add_u32 s42, s20, 14262272
    s_cmp_eq_u32 s17, 0
    s_cselect_b32 s39, s36, s38
    s_cmp_eq_u32 s17, 1
    s_cselect_b32 s39, s37, s39
    s_add_u32 s39, s39, 4096
    s_min_u32 s20, s17, 2
    s_mul_i32 s20, s20, 8704
    s_add_u32 s43, s20, 126976
    s_add_u32 s36, s36, s21
    s_add_u32 s37, s37, s21
    s_add_u32 s38, s38, s21
    s_mov_b32 s20, m0
    s_waitcnt vmcnt(8) lgkmcnt(0)
    s_barrier
    s_add_u32 m0, s21, 122880
    s_nop 0
    buffer_load_dwordx4 v2, s[8:11], s36 offen lds
    s_add_u32 m0, s21, 127488
    s_nop 0
    buffer_load_dwordx4 v15, s[8:11], s40 offen lds
    s_add_u32 m0, s21, 131584
    s_nop 0
    buffer_load_dwordx4 v2, s[8:11], s37 offen lds
    s_add_u32 m0, s21, 136192
    s_nop 0
    buffer_load_dwordx4 v15, s[8:11], s41 offen lds
    s_add_u32 m0, s21, 140288
    s_nop 0
    buffer_load_dwordx4 v2, s[8:11], s38 offen lds
    s_add_u32 m0, s21, 144896
    s_nop 0
    buffer_load_dwordx4 v15, s[8:11], s42 offen lds
    s_mov_b32 m0, s43
    s_mov_b32 exec_hi, 0
    buffer_load_dwordx4 v2, s[8:11], s39 offen lds
    s_mov_b32 exec_hi, -1
    s_mov_b32 m0, s20
    s_nop 0
    buffer_load_dwordx4 v2, s[8:11], s22 offen offset:0 lds
    buffer_load_dwordx4 v2, s[8:11], s22 offen offset:1024 lds
    buffer_load_dwordx4 v2, s[8:11], s22 offen offset:2048 lds
    buffer_load_dwordx4 v2, s[8:11], s22 offen offset:3072 lds
    s_add_u32 m0, m0, 16384
    s_add_u32 s22, s22, 16384
    buffer_load_dwordx4 v2, s[8:11], s22 offen offset:0 lds
    buffer_load_dwordx4 v2, s[8:11], s22 offen offset:1024 lds
    buffer_load_dwordx4 v2, s[8:11], s22 offen offset:2048 lds
    buffer_load_dwordx4 v2, s[8:11], s22 offen offset:3072 lds
    s_add_u32 m0, m0, 16384
    s_add_u32 s22, s22, 16384
    buffer_load_dwordx4 v2, s[8:11], s22 offen offset:0 lds
    buffer_load_dwordx4 v2, s[8:11], s22 offen offset:1024 lds
    buffer_load_dwordx4 v2, s[8:11], s22 offen offset:2048 lds
    buffer_load_dwordx4 v2, s[8:11], s22 offen offset:3072 lds
    s_add_u32 m0, m0, 16384
    s_add_u32 s22, s22, 16384
    s_lshl_b32 s19, s17, 11
    s_sub_u32 m0, m0, s19
    s_sub_u32 s22, s22, s19
    buffer_load_dwordx4 v2, s[8:11], s22 offen offset:0 lds
    buffer_load_dwordx4 v2, s[8:11], s22 offen offset:1024 lds
    s_waitcnt vmcnt(21)
    s_mov_b64 exec, 1
    ds_add_u32 v10, v144 offset:4
    s_mov_b64 exec, -1
    v_bfe_u32 v11, v1, 4, 1
    v_lshrrev_b32 v12, 5, v1
    v_bfe_u32 v13, v1, 2, 2
    v_and_b32 v14, 3, v1
    v_lshl_add_u32 v15, v11, 2, v14
    v_sub_u32 v3, v15, v12
    v_lshlrev_b32 v3, 3, v3
    v_sub_u32 v3, v3, v13
    v_lshlrev_b32 v3, 3, v3
    v_add_u32 v3, 122968, v3
    v_add_u32 v4, v15, v13
    v_lshl_add_u32 v4, v12, 3, v4
    v_lshlrev_b32 v4, 3, v4
    v_add_u32 v4, 127432, v4
    v_add_u32 v11, 1, v1
    v_and_b32 v11, 63, v11
    s_lshl_b32 s19, s17, 6
    s_add_u32 s20, s19, 149504
    v_lshl_add_u32 v8, v11, 2, s20
    s_sub_u32 s20, 149952, s19
    v_lshl_add_u32 v9, v11, 2, s20
    s_mov_b32 s28, 0
    s_brev_b32 s29, 1
    s_mul_i32 s32, s17, 5120
    s_add_u32 s32, s32, s24
    s_lshl_b32 s32, s32, 7
    s_add_u32 s32, s32, 16883712
    s_lshl_b32 s31, s31, 7
    s_add_u32 s33, s32, s31
    s_lshl_b32 s20, s17, 9
    s_sub_u32 s21, 3584, s20
    s_waitcnt vmcnt(14)
    s_waitcnt lgkmcnt(0)
    s_mov_b64 exec, 1
    ds_add_u32 v10, v144
    s_mov_b64 exec, -1
L_cv_spin_1:
    ds_read_b32 v13, v10
    s_waitcnt lgkmcnt(0)
    v_readfirstlane_b32 s19, v13
    s_cmp_lt_u32 s19, 4
    s_sleep 1
    s_cbranch_scc1 L_cv_spin_1
    v_mov_b32 v120, -1
    v_mov_b32 v121, -1
    v_mov_b32 v122, -1
    v_mov_b32 v123, -1
    s_lshr_b32 s19, s2, 5
    s_lshl2_add_u32 s19, s19, s17
    s_lshl_b32 s19, s19, 6
    s_add_u32 s19, s19, s16
    s_lshl2_add_u32 s46, s19, 10485760
    s_mul_i32 s19, s19, 1280
    s_add_u32 s19, s19, 7864320
    s_add_u32 s47, s19, 40960
    buffer_store_dwordx4 v[120:123], v2, s[8:11], s19 offen sc1
    buffer_store_dwordx4 v[120:123], v2, s[8:11], s47 offen sc1
    s_mov_b64 exec, 0xffff
    buffer_store_dwordx4 v[120:123], v2, s[8:11], s19 offen offset:1024 sc1
    buffer_store_dwordx4 v[120:123], v2, s[8:11], s47 offen offset:1024 sc1
    s_mov_b64 exec, -1
    s_mov_b32 s46, 131072
    s_setprio 2
    v_add_u32 v5, 0, v3
    s_add_u32 s19, s20, 0
    v_add_u32 v6, s19, v4
    s_add_u32 s19, s21, 0
    v_add_u32 v7, s19, v4
    ds_read_b64_tr_b16 v[16:17], v5 offset:32
    ds_read_b64_tr_b16 v[18:19], v5 offset:0
    ds_read_b64_tr_b16 v[48:49], v7 offset:384
    ds_read_b64_tr_b16 v[50:51], v7 offset:416
    ds_read_b64_tr_b16 v[32:33], v6 offset:384
    ds_read_b64_tr_b16 v[34:35], v6 offset:416
    ds_read_b64_tr_b16 v[20:21], v5 offset:160
    ds_read_b64_tr_b16 v[22:23], v5 offset:128
    ds_read_b64_tr_b16 v[52:53], v7 offset:256
    ds_read_b64_tr_b16 v[54:55], v7 offset:288
    ds_read_b64_tr_b16 v[36:37], v6 offset:256
    ds_read_b64_tr_b16 v[38:39], v6 offset:288
    s_waitcnt lgkmcnt(6)
    v_mfma_f32_32x32x16_bf16 v[80:95], v[16:19], v[48:51], 0
    ds_read_b64_tr_b16 v[24:25], v5 offset:288
    ds_read_b64_tr_b16 v[26:27], v5 offset:256
    ds_read_b64_tr_b16 v[56:57], v7 offset:128
    ds_read_b64_tr_b16 v[58:59], v7 offset:160
    ds_read_b64_tr_b16 v[40:41], v6 offset:128
    ds_read_b64_tr_b16 v[42:43], v6 offset:160
    v_mfma_f32_32x32x16_bf16 v[64:79], v[16:19], v[32:35], 0
    s_waitcnt lgkmcnt(6)
    v_mfma_f32_32x32x16_bf16 v[80:95], v[20:23], v[52:55], v[80:95]
    ds_read_b64_tr_b16 v[28:29], v5 offset:416
    ds_read_b64_tr_b16 v[30:31], v5 offset:384
    ds_read_b64_tr_b16 v[60:61], v7 offset:0
    ds_read_b64_tr_b16 v[62:63], v7 offset:32
    ds_read_b64_tr_b16 v[44:45], v6 offset:0
    ds_read_b64_tr_b16 v[46:47], v6 offset:32
    v_mfma_f32_32x32x16_bf16 v[64:79], v[20:23], v[36:39], v[64:79]
    v_add_u32 v5, 512, v5
    v_add_u32 v7, -512, v7
    v_add_u32 v6, -512, v6
    s_waitcnt lgkmcnt(6)
    v_mfma_f32_32x32x16_bf16 v[80:95], v[24:27], v[56:59], v[80:95]
    v_mfma_f32_32x32x16_bf16 v[64:79], v[24:27], v[40:43], v[64:79]
    s_waitcnt lgkmcnt(0)
    v_mfma_f32_32x32x16_bf16 v[80:95], v[28:31], v[60:63], v[80:95]
    v_mfma_f32_32x32x16_bf16 v[64:79], v[28:31], v[44:47], v[64:79]
    s_waitcnt vmcnt(0)
    s_mov_b64 exec, 1
    ds_add_u32 v10, v144 offset:8
    s_mov_b64 exec, -1
    s_mov_b32 s26, s17
    s_cmp_eq_u32 s26, 0
    s_cbranch_scc1 L_cv_p2s_5
L_cv_p1_3:
    ds_read_b64_tr_b16 v[16:17], v5 offset:32
    ds_read_b64_tr_b16 v[18:19], v5 offset:0
    ds_read_b64_tr_b16 v[48:49], v7 offset:384
    ds_read_b64_tr_b16 v[50:51], v7 offset:416
    ds_read_b64_tr_b16 v[32:33], v6 offset:384
    ds_read_b64_tr_b16 v[34:35], v6 offset:416
    ds_read_b64_tr_b16 v[20:21], v5 offset:160
    ds_read_b64_tr_b16 v[22:23], v5 offset:128
    ds_read_b64_tr_b16 v[52:53], v7 offset:256
    ds_read_b64_tr_b16 v[54:55], v7 offset:288
    ds_read_b64_tr_b16 v[36:37], v6 offset:256
    ds_read_b64_tr_b16 v[38:39], v6 offset:288
    s_waitcnt lgkmcnt(6)
    v_mfma_f32_32x32x16_bf16 v[80:95], v[16:19], v[48:51], v[80:95]
    ds_read_b64_tr_b16 v[24:25], v5 offset:288
    ds_read_b64_tr_b16 v[26:27], v5 offset:256
    ds_read_b64_tr_b16 v[56:57], v7 offset:128
    ds_read_b64_tr_b16 v[58:59], v7 offset:160
    ds_read_b64_tr_b16 v[40:41], v6 offset:128
    ds_read_b64_tr_b16 v[42:43], v6 offset:160
    v_mfma_f32_32x32x16_bf16 v[64:79], v[16:19], v[32:35], v[64:79]
    s_waitcnt lgkmcnt(6)
    v_mfma_f32_32x32x16_bf16 v[80:95], v[20:23], v[52:55], v[80:95]
    ds_read_b64_tr_b16 v[28:29], v5 offset:416
    ds_read_b64_tr_b16 v[30:31], v5 offset:384
    ds_read_b64_tr_b16 v[60:61], v7 offset:0
    ds_read_b64_tr_b16 v[62:63], v7 offset:32
    ds_read_b64_tr_b16 v[44:45], v6 offset:0
    ds_read_b64_tr_b16 v[46:47], v6 offset:32
    v_mfma_f32_32x32x16_bf16 v[64:79], v[20:23], v[36:39], v[64:79]
    v_add_u32 v5, 512, v5
    v_add_u32 v7, -512, v7
    v_add_u32 v6, -512, v6
    s_waitcnt lgkmcnt(6)
    v_mfma_f32_32x32x16_bf16 v[80:95], v[24:27], v[56:59], v[80:95]
    v_mfma_f32_32x32x16_bf16 v[64:79], v[24:27], v[40:43], v[64:79]
    s_waitcnt lgkmcnt(0)
    v_mfma_f32_32x32x16_bf16 v[80:95], v[28:31], v[60:63], v[80:95]
    v_mfma_f32_32x32x16_bf16 v[64:79], v[28:31], v[44:47], v[64:79]
    s_sub_u32 s26, s26, 1
    s_cmp_lg_u32 s26, 0
    s_cbranch_scc1 L_cv_p1_3
L_cv_p2s_5:
    s_lshl_b32 s26, s17, 1
    s_sub_u32 s26, 7, s26
L_cv_p2_4:
    ds_read_b64_tr_b16 v[16:17], v5 offset:32
    ds_read_b64_tr_b16 v[18:19], v5 offset:0
    ds_read_b64_tr_b16 v[48:49], v7 offset:384
    ds_read_b64_tr_b16 v[50:51], v7 offset:416
    ds_read_b64_tr_b16 v[20:21], v5 offset:160
    ds_read_b64_tr_b16 v[22:23], v5 offset:128
    ds_read_b64_tr_b16 v[52:53], v7 offset:256
    ds_read_b64_tr_b16 v[54:55], v7 offset:288
    ds_read_b64_tr_b16 v[24:25], v5 offset:288
    ds_read_b64_tr_b16 v[26:27], v5 offset:256
    ds_read_b64_tr_b16 v[56:57], v7 offset:128
    ds_read_b64_tr_b16 v[58:59], v7 offset:160
    s_waitcnt lgkmcnt(8)
    v_mfma_f32_32x32x16_bf16 v[80:95], v[16:19], v[48:51], v[80:95]
    ds_read_b64_tr_b16 v[28:29], v5 offset:416
    ds_read_b64_tr_b16 v[30:31], v5 offset:384
    ds_read_b64_tr_b16 v[60:61], v7 offset:0
    ds_read_b64_tr_b16 v[62:63], v7 offset:32
    s_waitcnt lgkmcnt(8)
    v_mfma_f32_32x32x16_bf16 v[80:95], v[20:23], v[52:55], v[80:95]
    v_add_u32 v5, 512, v5
    v_add_u32 v7, -512, v7
    s_waitcnt lgkmcnt(4)
    v_mfma_f32_32x32x16_bf16 v[80:95], v[24:27], v[56:59], v[80:95]
    s_waitcnt lgkmcnt(0)
    v_mfma_f32_32x32x16_bf16 v[80:95], v[28:31], v[60:63], v[80:95]
    s_sub_u32 s26, s26, 1
    s_cmp_lg_u32 s26, 0
    s_cbranch_scc1 L_cv_p2_4
    v_add_f32_dpp v66, v67, v66 wave_shr:1 row_mask:0xf bank_mask:0xf
    v_add_f32_dpp v70, v71, v70 wave_shr:1 row_mask:0xf bank_mask:0xf
    v_add_f32_dpp v74, v75, v74 wave_shr:1 row_mask:0xf bank_mask:0xf
    v_add_f32_dpp v78, v79, v78 wave_shr:1 row_mask:0xf bank_mask:0xf
    v_add_f32_dpp v65, v66, v65 wave_shr:1 row_mask:0xf bank_mask:0xf
    v_add_f32_dpp v69, v70, v69 wave_shr:1 row_mask:0xf bank_mask:0xf
    v_add_f32_dpp v73, v74, v73 wave_shr:1 row_mask:0xf bank_mask:0xf
    v_add_f32_dpp v77, v78, v77 wave_shr:1 row_mask:0xf bank_mask:0xf
    v_add_f32_dpp v96, v65, v64 wave_shr:1 row_mask:0xf bank_mask:0xf bound_ctrl:0
    v_add_f32_dpp v97, v69, v68 wave_shr:1 row_mask:0xf bank_mask:0xf bound_ctrl:0
    v_add_f32_dpp v98, v73, v72 wave_shr:1 row_mask:0xf bank_mask:0xf bound_ctrl:0
    v_add_f32_dpp v99, v77, v76 wave_shr:1 row_mask:0xf bank_mask:0xf bound_ctrl:0
    s_mov_b64 exec, s[28:29]
    ds_write_b128 v8, v[64:67] offset:16
    ds_write_b128 v8, v[68:71] offset:32
    ds_write_b128 v8, v[72:75] offset:48
    ds_write_b128 v8, v[76:79] offset:64
    s_mov_b64 exec, -1
    v_add_f32_dpp v82, v83, v82 wave_shr:1 row_mask:0xf bank_mask:0xf
    v_add_f32_dpp v86, v87, v86 wave_shr:1 row_mask:0xf bank_mask:0xf
    v_add_f32_dpp v90, v91, v90 wave_shr:1 row_mask:0xf bank_mask:0xf
    v_add_f32_dpp v94, v95, v94 wave_shr:1 row_mask:0xf bank_mask:0xf
    v_add_f32_dpp v81, v82, v81 wave_shr:1 row_mask:0xf bank_mask:0xf
    v_add_f32_dpp v85, v86, v85 wave_shr:1 row_mask:0xf bank_mask:0xf
    v_add_f32_dpp v89, v90, v89 wave_shr:1 row_mask:0xf bank_mask:0xf
    v_add_f32_dpp v93, v94, v93 wave_shr:1 row_mask:0xf bank_mask:0xf
    v_add_f32_dpp v100, v81, v80 wave_shr:1 row_mask:0xf bank_mask:0xf bound_ctrl:0
    v_add_f32_dpp v101, v85, v84 wave_shr:1 row_mask:0xf bank_mask:0xf bound_ctrl:0
    v_add_f32_dpp v102, v89, v88 wave_shr:1 row_mask:0xf bank_mask:0xf bound_ctrl:0
    v_add_f32_dpp v103, v93, v92 wave_shr:1 row_mask:0xf bank_mask:0xf bound_ctrl:0
    s_mov_b64 exec, s[28:29]
    ds_write_b128 v9, v[80:83] offset:16
    ds_write_b128 v9, v[84:87] offset:32
    ds_write_b128 v9, v[88:91] offset:48
    ds_write_b128 v9, v[92:95] offset:64
    s_mov_b64 exec, -1
L_cv_spin_6:
    ds_read_b32 v13, v10 offset:12
    s_waitcnt lgkmcnt(0)
    v_readfirstlane_b32 s19, v13
    s_cmp_lt_u32 s19, 8
    s_sleep 1
    s_cbranch_scc1 L_cv_spin_6
    s_mul_i32 m0, s17, 10240
    s_add_u32 s22, s23, m0
    s_add_u32 s22, s22, 122880
    buffer_load_dwordx4 v2, s[8:11], s22 offen offset:0 lds
    buffer_load_dwordx4 v2, s[8:11], s22 offen offset:1024 lds
    buffer_load_dwordx4 v2, s[8:11], s22 offen offset:2048 lds
    buffer_load_dwordx4 v2, s[8:11], s22 offen offset:3072 lds
    s_add_u32 m0, m0, 4096
    s_add_u32 s22, s22, 4096
    buffer_load_dwordx4 v2, s[8:11], s22 offen offset:0 lds
    buffer_load_dwordx4 v2, s[8:11], s22 offen offset:1024 lds
    buffer_load_dwordx4 v2, s[8:11], s22 offen offset:2048 lds
    buffer_load_dwordx4 v2, s[8:11], s22 offen offset:3072 lds
    s_add_u32 m0, m0, 4096
    s_add_u32 s22, s22, 4096
    buffer_load_dwordx4 v2, s[8:11], s22 offen offset:0 lds
    buffer_load_dwordx4 v2, s[8:11], s22 offen offset:1024 lds
    s_cmp_lg_u32 s17, 0
    s_cbranch_scc1 L_cv_na_7
    s_lshr_b32 s47, s2, 5
    s_lshl_b32 s47, s47, 7
    s_add_u32 s47, s47, 19505152
    s_mov_b64 exec, 1
    buffer_atomic_add v144, off, s[8:11], s47 sc1
    s_mov_b64 exec, -1
L_cv_na_7:
    s_lshr_b32 s19, s2, 3
    s_lshl2_add_u32 s19, s19, s17
    s_mul_i32 s19, s19, 6400
    s_mov_b32 exec_hi, 0x3ffff
    buffer_load_dword v120, v124, s[12:15], s19 offen
    s_mov_b32 exec_hi, -1
    v_add_u32 v5, 8704, v3
    s_add_u32 s19, s20, 8704
    v_add_u32 v6, s19, v4
    s_add_u32 s19, s21, 8704
    v_add_u32 v7, s19, v4
    ds_read_b64_tr_b16 v[16:17], v5 offset:32
    ds_read_b64_tr_b16 v[18:19], v5 offset:0
    ds_read_b64_tr_b16 v[48:49], v7 offset:384
    ds_read_b64_tr_b16 v[50:51], v7 offset:416
    ds_read_b64_tr_b16 v[32:33], v6 offset:384
    ds_read_b64_tr_b16 v[34:35], v6 offset:416
    ds_read_b64_tr_b16 v[20:21], v5 offset:160
    ds_read_b64_tr_b16 v[22:23], v5 offset:128
    ds_read_b64_tr_b16 v[52:53], v7 offset:256
    ds_read_b64_tr_b16 v[54:55], v7 offset:288
    ds_read_b64_tr_b16 v[36:37], v6 offset:256
    ds_read_b64_tr_b16 v[38:39], v6 offset:288
    s_waitcnt lgkmcnt(6)
    v_mfma_f32_32x32x16_bf16 v[80:95], v[16:19], v[48:51], 0
    ds_read_b64_tr_b16 v[24:25], v5 offset:288
    ds_read_b64_tr_b16 v[26:27], v5 offset:256
    ds_read_b64_tr_b16 v[56:57], v7 offset:128
    ds_read_b64_tr_b16 v[58:59], v7 offset:160
    ds_read_b64_tr_b16 v[40:41], v6 offset:128
    ds_read_b64_tr_b16 v[42:43], v6 offset:160
    v_mfma_f32_32x32x16_bf16 v[64:79], v[16:19], v[32:35], 0
    s_waitcnt lgkmcnt(6)
    v_mfma_f32_32x32x16_bf16 v[80:95], v[20:23], v[52:55], v[80:95]
    ds_read_b64_tr_b16 v[28:29], v5 offset:416
    ds_read_b64_tr_b16 v[30:31], v5 offset:384
    ds_read_b64_tr_b16 v[60:61], v7 offset:0
    ds_read_b64_tr_b16 v[62:63], v7 offset:32
    ds_read_b64_tr_b16 v[44:45], v6 offset:0
    ds_read_b64_tr_b16 v[46:47], v6 offset:32
    v_mfma_f32_32x32x16_bf16 v[64:79], v[20:23], v[36:39], v[64:79]
    v_add_u32 v5, 512, v5
    v_add_u32 v7, -512, v7
    v_add_u32 v6, -512, v6
    s_waitcnt lgkmcnt(6)
    v_mfma_f32_32x32x16_bf16 v[80:95], v[24:27], v[56:59], v[80:95]
    v_mfma_f32_32x32x16_bf16 v[64:79], v[24:27], v[40:43], v[64:79]
    s_waitcnt lgkmcnt(0)
    v_mfma_f32_32x32x16_bf16 v[80:95], v[28:31], v[60:63], v[80:95]
    v_mfma_f32_32x32x16_bf16 v[64:79], v[28:31], v[44:47], v[64:79]
    s_mov_b32 s26, s17
    s_cmp_eq_u32 s26, 0
    s_cbranch_scc1 L_cv_p2s_10
L_cv_p1_8:
    ds_read_b64_tr_b16 v[16:17], v5 offset:32
    ds_read_b64_tr_b16 v[18:19], v5 offset:0
    ds_read_b64_tr_b16 v[48:49], v7 offset:384
    ds_read_b64_tr_b16 v[50:51], v7 offset:416
    ds_read_b64_tr_b16 v[32:33], v6 offset:384
    ds_read_b64_tr_b16 v[34:35], v6 offset:416
    ds_read_b64_tr_b16 v[20:21], v5 offset:160
    ds_read_b64_tr_b16 v[22:23], v5 offset:128
    ds_read_b64_tr_b16 v[52:53], v7 offset:256
    ds_read_b64_tr_b16 v[54:55], v7 offset:288
    ds_read_b64_tr_b16 v[36:37], v6 offset:256
    ds_read_b64_tr_b16 v[38:39], v6 offset:288
    s_waitcnt lgkmcnt(6)
    v_mfma_f32_32x32x16_bf16 v[80:95], v[16:19], v[48:51], v[80:95]
    ds_read_b64_tr_b16 v[24:25], v5 offset:288
    ds_read_b64_tr_b16 v[26:27], v5 offset:256
    ds_read_b64_tr_b16 v[56:57], v7 offset:128
    ds_read_b64_tr_b16 v[58:59], v7 offset:160
    ds_read_b64_tr_b16 v[40:41], v6 offset:128
    ds_read_b64_tr_b16 v[42:43], v6 offset:160
    v_mfma_f32_32x32x16_bf16 v[64:79], v[16:19], v[32:35], v[64:79]
    s_waitcnt lgkmcnt(6)
    v_mfma_f32_32x32x16_bf16 v[80:95], v[20:23], v[52:55], v[80:95]
    ds_read_b64_tr_b16 v[28:29], v5 offset:416
    ds_read_b64_tr_b16 v[30:31], v5 offset:384
    ds_read_b64_tr_b16 v[60:61], v7 offset:0
    ds_read_b64_tr_b16 v[62:63], v7 offset:32
    ds_read_b64_tr_b16 v[44:45], v6 offset:0
    ds_read_b64_tr_b16 v[46:47], v6 offset:32
    v_mfma_f32_32x32x16_bf16 v[64:79], v[20:23], v[36:39], v[64:79]
    v_add_u32 v5, 512, v5
    v_add_u32 v7, -512, v7
    v_add_u32 v6, -512, v6
    s_waitcnt lgkmcnt(6)
    v_mfma_f32_32x32x16_bf16 v[80:95], v[24:27], v[56:59], v[80:95]
    v_mfma_f32_32x32x16_bf16 v[64:79], v[24:27], v[40:43], v[64:79]
    s_waitcnt lgkmcnt(0)
    v_mfma_f32_32x32x16_bf16 v[80:95], v[28:31], v[60:63], v[80:95]
    v_mfma_f32_32x32x16_bf16 v[64:79], v[28:31], v[44:47], v[64:79]
    s_sub_u32 s26, s26, 1
    s_cmp_lg_u32 s26, 0
    s_cbranch_scc1 L_cv_p1_8
L_cv_p2s_10:
    s_lshl_b32 s26, s17, 1
    s_sub_u32 s26, 7, s26
L_cv_p2_9:
    ds_read_b64_tr_b16 v[16:17], v5 offset:32
    ds_read_b64_tr_b16 v[18:19], v5 offset:0
    ds_read_b64_tr_b16 v[48:49], v7 offset:384
    ds_read_b64_tr_b16 v[50:51], v7 offset:416
    ds_read_b64_tr_b16 v[20:21], v5 offset:160
    ds_read_b64_tr_b16 v[22:23], v5 offset:128
    ds_read_b64_tr_b16 v[52:53], v7 offset:256
    ds_read_b64_tr_b16 v[54:55], v7 offset:288
    ds_read_b64_tr_b16 v[24:25], v5 offset:288
    ds_read_b64_tr_b16 v[26:27], v5 offset:256
    ds_read_b64_tr_b16 v[56:57], v7 offset:128
    ds_read_b64_tr_b16 v[58:59], v7 offset:160
    s_waitcnt lgkmcnt(8)
    v_mfma_f32_32x32x16_bf16 v[80:95], v[16:19], v[48:51], v[80:95]
    ds_read_b64_tr_b16 v[28:29], v5 offset:416
    ds_read_b64_tr_b16 v[30:31], v5 offset:384
    ds_read_b64_tr_b16 v[60:61], v7 offset:0
    ds_read_b64_tr_b16 v[62:63], v7 offset:32
    s_waitcnt lgkmcnt(8)
    v_mfma_f32_32x32x16_bf16 v[80:95], v[20:23], v[52:55], v[80:95]
    v_add_u32 v5, 512, v5
    v_add_u32 v7, -512, v7
    s_waitcnt lgkmcnt(4)
    v_mfma_f32_32x32x16_bf16 v[80:95], v[24:27], v[56:59], v[80:95]
    s_waitcnt lgkmcnt(0)
    v_mfma_f32_32x32x16_bf16 v[80:95], v[28:31], v[60:63], v[80:95]
    s_sub_u32 s26, s26, 1
    s_cmp_lg_u32 s26, 0
    s_cbranch_scc1 L_cv_p2_9
    v_add_f32_dpp v66, v67, v66 wave_shr:1 row_mask:0xf bank_mask:0xf
    v_add_f32_dpp v70, v71, v70 wave_shr:1 row_mask:0xf bank_mask:0xf
    v_add_f32_dpp v74, v75, v74 wave_shr:1 row_mask:0xf bank_mask:0xf
    v_add_f32_dpp v78, v79, v78 wave_shr:1 row_mask:0xf bank_mask:0xf
    v_add_f32_dpp v65, v66, v65 wave_shr:1 row_mask:0xf bank_mask:0xf
    v_add_f32_dpp v69, v70, v69 wave_shr:1 row_mask:0xf bank_mask:0xf
    v_add_f32_dpp v73, v74, v73 wave_shr:1 row_mask:0xf bank_mask:0xf
    v_add_f32_dpp v77, v78, v77 wave_shr:1 row_mask:0xf bank_mask:0xf
    v_add_f32_dpp v104, v65, v64 wave_shr:1 row_mask:0xf bank_mask:0xf bound_ctrl:0
    v_add_f32_dpp v105, v69, v68 wave_shr:1 row_mask:0xf bank_mask:0xf bound_ctrl:0
    v_add_f32_dpp v106, v73, v72 wave_shr:1 row_mask:0xf bank_mask:0xf bound_ctrl:0
    v_add_f32_dpp v107, v77, v76 wave_shr:1 row_mask:0xf bank_mask:0xf bound_ctrl:0
    s_mov_b64 exec, s[28:29]
    ds_write_b128 v8, v[64:67] offset:544
    ds_write_b128 v8, v[68:71] offset:560
    ds_write_b128 v8, v[72:75] offset:576
    ds_write_b128 v8, v[76:79] offset:592
    s_mov_b64 exec, -1
    v_add_f32_dpp v82, v83, v82 wave_shr:1 row_mask:0xf bank_mask:0xf
    v_add_f32_dpp v86, v87, v86 wave_shr:1 row_mask:0xf bank_mask:0xf
    v_add_f32_dpp v90, v91, v90 wave_shr:1 row_mask:0xf bank_mask:0xf
    v_add_f32_dpp v94, v95, v94 wave_shr:1 row_mask:0xf bank_mask:0xf
    v_add_f32_dpp v81, v82, v81 wave_shr:1 row_mask:0xf bank_mask:0xf
    v_add_f32_dpp v85, v86, v85 wave_shr:1 row_mask:0xf bank_mask:0xf
    v_add_f32_dpp v89, v90, v89 wave_shr:1 row_mask:0xf bank_mask:0xf
    v_add_f32_dpp v93, v94, v93 wave_shr:1 row_mask:0xf bank_mask:0xf
    v_add_f32_dpp v108, v81, v80 wave_shr:1 row_mask:0xf bank_mask:0xf bound_ctrl:0
    v_add_f32_dpp v109, v85, v84 wave_shr:1 row_mask:0xf bank_mask:0xf bound_ctrl:0
    v_add_f32_dpp v110, v89, v88 wave_shr:1 row_mask:0xf bank_mask:0xf bound_ctrl:0
    v_add_f32_dpp v111, v93, v92 wave_shr:1 row_mask:0xf bank_mask:0xf bound_ctrl:0
    s_mov_b64 exec, s[28:29]
    ds_write_b128 v9, v[80:83] offset:544
    ds_write_b128 v9, v[84:87] offset:560
    ds_write_b128 v9, v[88:91] offset:576
    ds_write_b128 v9, v[92:95] offset:592
    s_mov_b64 exec, -1
    s_and_b32 s47, s2, 7
    s_lshl_b32 s47, s47, 7
    s_add_u32 s47, s47, 19505152
L_cv_gw_11:
    buffer_load_dword v13, off, s[8:11], s47 sc1
    s_waitcnt vmcnt(0)
    v_readfirstlane_b32 s19, v13
    s_cmp_ge_u32 s19, 32
    s_cbranch_scc1 L_cv_gd_12
    s_sleep 4
    s_sub_u32 s46, s46, 1
    s_cbranch_scc0 L_cv_gw_11
    s_mov_b32 s46, 0
L_cv_gd_12:
    s_mov_b64 exec, 1
    ds_add_u32 v10, v144 offset:20
    s_mov_b64 exec, -1
    s_cmp_lt_u32 s25, 3
    s_cbranch_scc1 L_cv_sync_2
    v_add_u32 v5, 17408, v3
    s_add_u32 s19, s20, 17408
    v_add_u32 v6, s19, v4
    s_add_u32 s19, s21, 17408
    v_add_u32 v7, s19, v4
    ds_read_b64_tr_b16 v[16:17], v5 offset:32
    ds_read_b64_tr_b16 v[18:19], v5 offset:0
    ds_read_b64_tr_b16 v[48:49], v7 offset:384
    ds_read_b64_tr_b16 v[50:51], v7 offset:416
    ds_read_b64_tr_b16 v[32:33], v6 offset:384
    ds_read_b64_tr_b16 v[34:35], v6 offset:416
    ds_read_b64_tr_b16 v[20:21], v5 offset:160
    ds_read_b64_tr_b16 v[22:23], v5 offset:128
    ds_read_b64_tr_b16 v[52:53], v7 offset:256
    ds_read_b64_tr_b16 v[54:55], v7 offset:288
    ds_read_b64_tr_b16 v[36:37], v6 offset:256
    ds_read_b64_tr_b16 v[38:39], v6 offset:288
    s_waitcnt lgkmcnt(6)
    v_mfma_f32_32x32x16_bf16 v[80:95], v[16:19], v[48:51], 0
    ds_read_b64_tr_b16 v[24:25], v5 offset:288
    ds_read_b64_tr_b16 v[26:27], v5 offset:256
    ds_read_b64_tr_b16 v[56:57], v7 offset:128
    ds_read_b64_tr_b16 v[58:59], v7 offset:160
    ds_read_b64_tr_b16 v[40:41], v6 offset:128
    ds_read_b64_tr_b16 v[42:43], v6 offset:160
    v_mfma_f32_32x32x16_bf16 v[64:79], v[16:19], v[32:35], 0
    s_waitcnt lgkmcnt(6)
    v_mfma_f32_32x32x16_bf16 v[80:95], v[20:23], v[52:55], v[80:95]
    ds_read_b64_tr_b16 v[28:29], v5 offset:416
    ds_read_b64_tr_b16 v[30:31], v5 offset:384
    ds_read_b64_tr_b16 v[60:61], v7 offset:0
    ds_read_b64_tr_b16 v[62:63], v7 offset:32
    ds_read_b64_tr_b16 v[44:45], v6 offset:0
    ds_read_b64_tr_b16 v[46:47], v6 offset:32
    v_mfma_f32_32x32x16_bf16 v[64:79], v[20:23], v[36:39], v[64:79]
    v_add_u32 v5, 512, v5
    v_add_u32 v7, -512, v7
    v_add_u32 v6, -512, v6
    s_waitcnt lgkmcnt(6)
    v_mfma_f32_32x32x16_bf16 v[80:95], v[24:27], v[56:59], v[80:95]
    v_mfma_f32_32x32x16_bf16 v[64:79], v[24:27], v[40:43], v[64:79]
    s_waitcnt lgkmcnt(0)
    v_mfma_f32_32x32x16_bf16 v[80:95], v[28:31], v[60:63], v[80:95]
    v_mfma_f32_32x32x16_bf16 v[64:79], v[28:31], v[44:47], v[64:79]
    s_mov_b32 s26, s17
    s_cmp_eq_u32 s26, 0
    s_cbranch_scc1 L_cv_p2s_15
L_cv_p1_13:
    ds_read_b64_tr_b16 v[16:17], v5 offset:32
    ds_read_b64_tr_b16 v[18:19], v5 offset:0
    ds_read_b64_tr_b16 v[48:49], v7 offset:384
    ds_read_b64_tr_b16 v[50:51], v7 offset:416
    ds_read_b64_tr_b16 v[32:33], v6 offset:384
    ds_read_b64_tr_b16 v[34:35], v6 offset:416
    ds_read_b64_tr_b16 v[20:21], v5 offset:160
    ds_read_b64_tr_b16 v[22:23], v5 offset:128
    ds_read_b64_tr_b16 v[52:53], v7 offset:256
    ds_read_b64_tr_b16 v[54:55], v7 offset:288
    ds_read_b64_tr_b16 v[36:37], v6 offset:256
    ds_read_b64_tr_b16 v[38:39], v6 offset:288
    s_waitcnt lgkmcnt(6)
    v_mfma_f32_32x32x16_bf16 v[80:95], v[16:19], v[48:51], v[80:95]
    ds_read_b64_tr_b16 v[24:25], v5 offset:288
    ds_read_b64_tr_b16 v[26:27], v5 offset:256
    ds_read_b64_tr_b16 v[56:57], v7 offset:128
    ds_read_b64_tr_b16 v[58:59], v7 offset:160
    ds_read_b64_tr_b16 v[40:41], v6 offset:128
    ds_read_b64_tr_b16 v[42:43], v6 offset:160
    v_mfma_f32_32x32x16_bf16 v[64:79], v[16:19], v[32:35], v[64:79]
    s_waitcnt lgkmcnt(6)
    v_mfma_f32_32x32x16_bf16 v[80:95], v[20:23], v[52:55], v[80:95]
    ds_read_b64_tr_b16 v[28:29], v5 offset:416
    ds_read_b64_tr_b16 v[30:31], v5 offset:384
    ds_read_b64_tr_b16 v[60:61], v7 offset:0
    ds_read_b64_tr_b16 v[62:63], v7 offset:32
    ds_read_b64_tr_b16 v[44:45], v6 offset:0
    ds_read_b64_tr_b16 v[46:47], v6 offset:32
    v_mfma_f32_32x32x16_bf16 v[64:79], v[20:23], v[36:39], v[64:79]
    v_add_u32 v5, 512, v5
    v_add_u32 v7, -512, v7
    v_add_u32 v6, -512, v6
    s_waitcnt lgkmcnt(6)
    v_mfma_f32_32x32x16_bf16 v[80:95], v[24:27], v[56:59], v[80:95]
    v_mfma_f32_32x32x16_bf16 v[64:79], v[24:27], v[40:43], v[64:79]
    s_waitcnt lgkmcnt(0)
    v_mfma_f32_32x32x16_bf16 v[80:95], v[28:31], v[60:63], v[80:95]
    v_mfma_f32_32x32x16_bf16 v[64:79], v[28:31], v[44:47], v[64:79]
    s_sub_u32 s26, s26, 1
    s_cmp_lg_u32 s26, 0
    s_cbranch_scc1 L_cv_p1_13
L_cv_p2s_15:
    s_lshl_b32 s26, s17, 1
    s_sub_u32 s26, 7, s26
L_cv_p2_14:
    ds_read_b64_tr_b16 v[16:17], v5 offset:32
    ds_read_b64_tr_b16 v[18:19], v5 offset:0
    ds_read_b64_tr_b16 v[48:49], v7 offset:384
    ds_read_b64_tr_b16 v[50:51], v7 offset:416
    ds_read_b64_tr_b16 v[20:21], v5 offset:160
    ds_read_b64_tr_b16 v[22:23], v5 offset:128
    ds_read_b64_tr_b16 v[52:53], v7 offset:256
    ds_read_b64_tr_b16 v[54:55], v7 offset:288
    ds_read_b64_tr_b16 v[24:25], v5 offset:288
    ds_read_b64_tr_b16 v[26:27], v5 offset:256
    ds_read_b64_tr_b16 v[56:57], v7 offset:128
    ds_read_b64_tr_b16 v[58:59], v7 offset:160
    s_waitcnt lgkmcnt(8)
    v_mfma_f32_32x32x16_bf16 v[80:95], v[16:19], v[48:51], v[80:95]
    ds_read_b64_tr_b16 v[28:29], v5 offset:416
    ds_read_b64_tr_b16 v[30:31], v5 offset:384
    ds_read_b64_tr_b16 v[60:61], v7 offset:0
    ds_read_b64_tr_b16 v[62:63], v7 offset:32
    s_waitcnt lgkmcnt(8)
    v_mfma_f32_32x32x16_bf16 v[80:95], v[20:23], v[52:55], v[80:95]
    v_add_u32 v5, 512, v5
    v_add_u32 v7, -512, v7
    s_waitcnt lgkmcnt(4)
    v_mfma_f32_32x32x16_bf16 v[80:95], v[24:27], v[56:59], v[80:95]
    s_waitcnt lgkmcnt(0)
    v_mfma_f32_32x32x16_bf16 v[80:95], v[28:31], v[60:63], v[80:95]
    s_sub_u32 s26, s26, 1
    s_cmp_lg_u32 s26, 0
    s_cbranch_scc1 L_cv_p2_14
    v_add_f32_dpp v66, v67, v66 wave_shr:1 row_mask:0xf bank_mask:0xf
    v_add_f32_dpp v70, v71, v70 wave_shr:1 row_mask:0xf bank_mask:0xf
    v_add_f32_dpp v74, v75, v74 wave_shr:1 row_mask:0xf bank_mask:0xf
    v_add_f32_dpp v78, v79, v78 wave_shr:1 row_mask:0xf bank_mask:0xf
    v_add_f32_dpp v65, v66, v65 wave_shr:1 row_mask:0xf bank_mask:0xf
    v_add_f32_dpp v69, v70, v69 wave_shr:1 row_mask:0xf bank_mask:0xf
    v_add_f32_dpp v73, v74, v73 wave_shr:1 row_mask:0xf bank_mask:0xf
    v_add_f32_dpp v77, v78, v77 wave_shr:1 row_mask:0xf bank_mask:0xf
    v_add_f32_dpp v112, v65, v64 wave_shr:1 row_mask:0xf bank_mask:0xf bound_ctrl:0
    v_add_f32_dpp v113, v69, v68 wave_shr:1 row_mask:0xf bank_mask:0xf bound_ctrl:0
    v_add_f32_dpp v114, v73, v72 wave_shr:1 row_mask:0xf bank_mask:0xf bound_ctrl:0
    v_add_f32_dpp v115, v77, v76 wave_shr:1 row_mask:0xf bank_mask:0xf bound_ctrl:0
    s_mov_b64 exec, s[28:29]
    ds_write_b128 v8, v[64:67] offset:1072
    ds_write_b128 v8, v[68:71] offset:1088
    ds_write_b128 v8, v[72:75] offset:1104
    ds_write_b128 v8, v[76:79] offset:1120
    s_mov_b64 exec, -1
    v_add_f32_dpp v82, v83, v82 wave_shr:1 row_mask:0xf bank_mask:0xf
    v_add_f32_dpp v86, v87, v86 wave_shr:1 row_mask:0xf bank_mask:0xf
    v_add_f32_dpp v90, v91, v90 wave_shr:1 row_mask:0xf bank_mask:0xf
    v_add_f32_dpp v94, v95, v94 wave_shr:1 row_mask:0xf bank_mask:0xf
    v_add_f32_dpp v81, v82, v81 wave_shr:1 row_mask:0xf bank_mask:0xf
    v_add_f32_dpp v85, v86, v85 wave_shr:1 row_mask:0xf bank_mask:0xf
    v_add_f32_dpp v89, v90, v89 wave_shr:1 row_mask:0xf bank_mask:0xf
    v_add_f32_dpp v93, v94, v93 wave_shr:1 row_mask:0xf bank_mask:0xf
    v_add_f32_dpp v116, v81, v80 wave_shr:1 row_mask:0xf bank_mask:0xf bound_ctrl:0
    v_add_f32_dpp v117, v85, v84 wave_shr:1 row_mask:0xf bank_mask:0xf bound_ctrl:0
    v_add_f32_dpp v118, v89, v88 wave_shr:1 row_mask:0xf bank_mask:0xf bound_ctrl:0
    v_add_f32_dpp v119, v93, v92 wave_shr:1 row_mask:0xf bank_mask:0xf bound_ctrl:0
    s_mov_b64 exec, s[28:29]
    ds_write_b128 v9, v[80:83] offset:1072
    ds_write_b128 v9, v[84:87] offset:1088
    ds_write_b128 v9, v[88:91] offset:1104
    ds_write_b128 v9, v[92:95] offset:1120
    s_mov_b64 exec, -1
L_cv_sync_2:
    s_waitcnt lgkmcnt(0)
    s_mov_b64 exec, 1
    ds_add_u32 v10, v144
    s_mov_b64 exec, -1
L_cv_spin_16:
    ds_read_b32 v13, v10
    s_waitcnt lgkmcnt(0)
    v_readfirstlane_b32 s19, v13
    s_cmp_lt_u32 s19, 8
    s_sleep 1
    s_cbranch_scc1 L_cv_spin_16
    ds_read2_b32 v[120:121], v8 offset0:0 offset1:4
    ds_read2_b32 v[122:123], v8 offset0:8 offset1:12
    ds_read2_b32 v[124:125], v9 offset0:0 offset1:4
    ds_read2_b32 v[126:127], v9 offset0:8 offset1:12
    ds_read2_b32 v[128:129], v8 offset0:132 offset1:136
    ds_read2_b32 v[130:131], v8 offset0:140 offset1:144
    ds_read2_b32 v[132:133], v9 offset0:132 offset1:136
    ds_read2_b32 v[134:135], v9 offset0:140 offset1:144
    v_add_u32 v8, 1056, v8
    v_add_u32 v9, 1056, v9
    ds_read2_b32 v[136:137], v8 offset0:0 offset1:4
    ds_read2_b32 v[138:139], v8 offset0:8 offset1:12
    ds_read2_b32 v[140:141], v9 offset0:0 offset1:4
    ds_read2_b32 v[142:143], v9 offset0:8 offset1:12
    s_waitcnt lgkmcnt(0)
    s_mov_b64 exec, 7
    v_pk_add_f32 v[96:97], v[96:97], v[120:121]
    v_pk_add_f32 v[98:99], v[98:99], v[122:123]
    v_pk_add_f32 v[100:101], v[100:101], v[124:125]
    v_pk_add_f32 v[102:103], v[102:103], v[126:127]
    v_pk_add_f32 v[104:105], v[104:105], v[128:129]
    v_pk_add_f32 v[106:107], v[106:107], v[130:131]
    v_pk_add_f32 v[108:109], v[108:109], v[132:133]
    v_pk_add_f32 v[110:111], v[110:111], v[134:135]
    v_pk_add_f32 v[112:113], v[112:113], v[136:137]
    v_pk_add_f32 v[114:115], v[114:115], v[138:139]
    v_pk_add_f32 v[116:117], v[116:117], v[140:141]
    v_pk_add_f32 v[118:119], v[118:119], v[142:143]
    s_mov_b64 exec, -1
    v_lshrrev_b32 v14, 3, v1
    v_mul_u32_u24 v14, 81792, v14
    v_add_u32 v14, v14, v2
    v_cvt_pk_bf16_f32 v96, v96, v97
    v_cvt_pk_bf16_f32 v97, v98, v99
    v_cvt_pk_bf16_f32 v98, v100, v101
    v_cvt_pk_bf16_f32 v99, v102, v103
    buffer_store_dwordx4 v[96:99], v14, s[8:11], s32 offen offset:0 sc1
    v_cvt_pk_bf16_f32 v104, v104, v105
    v_cvt_pk_bf16_f32 v105, v106, v107
    v_cvt_pk_bf16_f32 v106, v108, v109
    v_cvt_pk_bf16_f32 v107, v110, v111
    buffer_store_dwordx4 v[104:107], v14, s[8:11], s32 offen offset:128 sc1
    s_cmp_lt_u32 s25, 3
    s_cbranch_scc1 L_cv_two_17
    v_cvt_pk_bf16_f32 v112, v112, v113
    v_cvt_pk_bf16_f32 v113, v114, v115
    v_cvt_pk_bf16_f32 v114, v116, v117
    v_cvt_pk_bf16_f32 v115, v118, v119
    buffer_store_dwordx4 v[112:115], v14, s[8:11], s33 offen offset:0 sc1
L_cv_two_17:
    s_setprio 3
    v_bfe_u32 v11, v1, 1, 2
    v_mul_u32_u24 v11, 80, v11
    v_and_or_b32 v11, v1, 1, v11
    v_bfe_u32 v13, v1, 3, 1
    v_bfe_u32 v15, v1, 4, 1
    v_lshrrev_b32 v12, 5, v1
    v_mad_u32_u24 v16, v12, 5, v15
    v_lshl_add_u32 v16, v13, 1, v16
    v_mul_u32_u24 v16, 5120, v16
    v_lshl_add_u32 v16, v11, 4, v16
    v_lshl_add_u32 v12, v12, 1, v13
    s_bfe_u32 s26, s2, 0x20005
    v_xor_b32 v12, s26, v12
    v_lshl_add_u32 v12, v12, 2, v15
    v_mul_u32_u24 v12, 25600, v12
    v_lshl_add_u32 v17, v11, 4, v12
    s_lshr_b32 s19, s17, 1
    s_lshr_b32 s20, s2, 7
    s_xor_b32 s19, s19, s20
    s_mul_i32 s22, s19, 409600
    s_bitcmp0_b32 s17, 0
    s_cselect_b32 s19, 51200, 0
    s_add_u32 s22, s22, s19
    s_lshr_b32 s19, s2, 5
    s_mul_i32 s19, s19, 160
    s_add_u32 s22, s22, s19
    s_add_u32 s23, s22, 20480
    s_mul_i32 s20, s17, 20480
    s_cmp_eq_u32 s17, 3
    s_cselect_b32 s20, 81920, s20
    s_add_u32 m0, s20, 40960
    s_waitcnt vmcnt(0)
    s_waitcnt lgkmcnt(0)
    s_mov_b64 exec, 1
    ds_add_u32 v10, v144
    s_mov_b64 exec, -1
L_cv_spin_18:
    ds_read_b32 v13, v10
    s_waitcnt lgkmcnt(0)
    v_readfirstlane_b32 s19, v13
    s_cmp_ge_u32 s19, 12
    s_cbranch_scc1 L_cv_ok_19
    s_sleep 1
    s_branch L_cv_spin_18
L_cv_ok_19:
    s_cmp_lg_u32 s17, 0
    s_cbranch_scc1 L_cv_na_20
    s_and_b32 s47, s2, 7
    s_lshl_b32 s47, s47, 7
    s_add_u32 s47, s47, 19506176
    s_mov_b64 exec, 1
    buffer_atomic_add v144, off, s[8:11], s47 sc1
    s_mov_b64 exec, -1
L_cv_na_20:
L_cv_spin_21:
    ds_read_b32 v13, v10 offset:24
    s_waitcnt lgkmcnt(0)
    v_readfirstlane_b32 s19, v13
    s_cmp_ge_u32 s19, 8
    s_cbranch_scc1 L_cv_ok_22
    s_sleep 8
    s_branch L_cv_spin_21
L_cv_ok_22:
    s_xor_b32 s20, s26, 0
    s_mul_i32 s20, s20, 102400
    s_add_u32 s20, s20, s22
    buffer_load_dwordx4 v16, s[12:15], s20 offen offset:0  lds
    s_add_u32 m0, m0, 992
    s_nop 0
    buffer_load_dwordx4 v16, s[12:15], s20 offen offset:32  lds
    s_add_u32 m0, m0, 992
    s_nop 0
    buffer_load_dwordx4 v16, s[12:15], s20 offen offset:64  lds
    s_add_u32 m0, m0, 992
    s_nop 0
    buffer_load_dwordx4 v16, s[12:15], s20 offen offset:96  lds
    s_add_u32 m0, m0, 992
    s_nop 0
    buffer_load_dwordx4 v16, s[12:15], s20 offen offset:128  lds
    s_add_u32 m0, m0, 1152
    s_xor_b32 s20, s26, 1
    s_mul_i32 s20, s20, 102400
    s_add_u32 s20, s20, s22
    buffer_load_dwordx4 v16, s[12:15], s20 offen offset:0  lds
    s_add_u32 m0, m0, 992
    s_nop 0
    buffer_load_dwordx4 v16, s[12:15], s20 offen offset:32  lds
    s_add_u32 m0, m0, 992
    s_nop 0
    buffer_load_dwordx4 v16, s[12:15], s20 offen offset:64  lds
    s_add_u32 m0, m0, 992
    s_nop 0
    buffer_load_dwordx4 v16, s[12:15], s20 offen offset:96  lds
    s_add_u32 m0, m0, 992
    s_nop 0
    buffer_load_dwordx4 v16, s[12:15], s20 offen offset:128  lds
    s_add_u32 m0, m0, 1152
    s_xor_b32 s20, s26, 2
    s_mul_i32 s20, s20, 102400
    s_add_u32 s20, s20, s22
    buffer_load_dwordx4 v16, s[12:15], s20 offen offset:0  lds
    s_add_u32 m0, m0, 992
    s_nop 0
    buffer_load_dwordx4 v16, s[12:15], s20 offen offset:32  lds
    s_add_u32 m0, m0, 992
    s_nop 0
    buffer_load_dwordx4 v16, s[12:15], s20 offen offset:64  lds
    s_add_u32 m0, m0, 992
    s_nop 0
    buffer_load_dwordx4 v16, s[12:15], s20 offen offset:96  lds
    s_add_u32 m0, m0, 992
    s_nop 0
    buffer_load_dwordx4 v16, s[12:15], s20 offen offset:128  lds
    s_add_u32 m0, m0, 1152
    s_xor_b32 s20, s26, 3
    s_mul_i32 s20, s20, 102400
    s_add_u32 s20, s20, s22
    buffer_load_dwordx4 v16, s[12:15], s20 offen offset:0  lds
    s_add_u32 m0, m0, 992
    s_nop 0
    buffer_load_dwordx4 v16, s[12:15], s20 offen offset:32  lds
    s_add_u32 m0, m0, 992
    s_nop 0
    buffer_load_dwordx4 v16, s[12:15], s20 offen offset:64  lds
    s_add_u32 m0, m0, 992
    s_nop 0
    buffer_load_dwordx4 v16, s[12:15], s20 offen offset:96  lds
    s_add_u32 m0, m0, 992
    s_nop 0
    buffer_load_dwordx4 v16, s[12:15], s20 offen offset:128  lds
    s_add_u32 m0, m0, 1152
    s_cmp_eq_u32 s25, 3
    s_cbranch_scc1 L_noy
    s_lshr_b32 s30, s2, 3
    s_and_b32 s31, s2, 7
    s_lshl3_add_u32 s33, s30, s31
    s_mul_i32 s33, s33, 10
    s_add_u32 s33, s33, s17
    s_lshl_b32 s33, s33, 10
    s_add_u32 s33, s33, 16883712
    s_lshl_b32 s20, s17, 10
    s_add_u32 s20, s20, 151168
    v_add_u32 v7, s20, v2
    s_mov_b32 s36, s44
    s_mov_b32 s37, s45
    s_mov_b32 s38, 5242880
    s_mov_b32 s39, 0x00020000
    v_lshrrev_b32 v11, 4, v1
    v_bfe_u32 v12, v1, 2, 2
    v_lshl_add_u32 v12, v11, 3, v12
    s_lshl_b32 s20, s17, 5
    s_add_u32 s20, s20, 151168
    v_lshl_add_u32 v5, v12, 7, s20
    v_and_b32 v12, 3, v1
    v_lshl_add_u32 v5, v12, 3, v5
    s_lshr_b32 s20, s30, 3
    v_bfe_i32 v13, v1, 2, 1
    v_and_b32 v13, 7, v13
    v_xor_b32 v13, s20, v13
    v_lshl_add_u32 v12, v13, 2, v12
    v_bfe_u32 v13, v1, 3, 1
    v_lshl_add_u32 v12, v12, 6, v13
    v_mul_u32_u24 v12, 2560, v12
    v_lshl_add_u32 v6, v11, 4, v12
    s_and_b32 s32, s30, 7
    s_lshl2_add_u32 s32, s32, s17
    s_mul_i32 s32, s32, 5120
    s_mul_i32 s20, s31, 160
    s_add_u32 s32, s32, s20
    s_add_u32 s32, s32, 1280
    s_cmp_lt_u32 s17, 2
    s_cselect_b64 s[28:29], -1, 0
    s_and_b32 s47, s2, 7
    s_lshl_b32 s47, s47, 7
    s_add_u32 s47, s47, 19506176
L_cv_gw_23:
    buffer_load_dword v13, off, s[8:11], s47 sc1
    s_waitcnt vmcnt(0)
    v_readfirstlane_b32 s19, v13
    s_cmp_ge_u32 s19, 32
    s_cbranch_scc1 L_cv_gd_24
    s_sleep 4
    s_sub_u32 s46, s46, 1
    s_cbranch_scc0 L_cv_gw_23
    s_mov_b32 s46, 0
L_cv_gd_24:
    buffer_load_dwordx4 v[32:35], v2, s[8:11], s33 offen sc1
    s_add_u32 s33, s33, 4096
    buffer_load_dwordx4 v[36:39], v2, s[8:11], s33 offen sc1
    s_add_u32 s33, s33, 4096
    s_mov_b64 exec, s[28:29]
    buffer_load_dwordx4 v[40:43], v2, s[8:11], s33 offen sc1
    s_add_u32 s33, s33, 4294795264
    s_mov_b64 exec, -1
    buffer_load_dwordx4 v[44:47], v2, s[8:11], s33 offen sc1
    s_add_u32 s33, s33, 4096
    buffer_load_dwordx4 v[48:51], v2, s[8:11], s33 offen sc1
    s_add_u32 s33, s33, 4096
    s_mov_b64 exec, s[28:29]
    buffer_load_dwordx4 v[52:55], v2, s[8:11], s33 offen sc1
    s_add_u32 s33, s33, 4294795264
    s_mov_b64 exec, -1
    s_waitcnt vmcnt(5)
    ds_write_b128 v7, v[32:35] offset:0
    s_waitcnt vmcnt(4)
    ds_write_b128 v7, v[36:39] offset:4096
    s_mov_b64 exec, s[28:29]
    s_waitcnt vmcnt(3)
    ds_write_b128 v7, v[40:43] offset:8192
    s_mov_b64 exec, -1
    s_waitcnt lgkmcnt(0)
    s_mov_b64 exec, 1
    ds_add_u32 v10, v144
    s_mov_b64 exec, -1
L_cv_spin_25:
    ds_read_b32 v13, v10
    s_waitcnt lgkmcnt(0)
    v_readfirstlane_b32 s19, v13
    s_cmp_ge_u32 s19, 16
    s_cbranch_scc1 L_cv_ok_26
    s_sleep 1
    s_branch L_cv_spin_25
L_cv_ok_26:
    ds_read_b64_tr_b16 v[32:33], v5 offset:0
    ds_read_b64_tr_b16 v[34:35], v5 offset:512
    ds_read_b64_tr_b16 v[36:37], v5 offset:4096
    ds_read_b64_tr_b16 v[38:39], v5 offset:4608
    ds_read_b64_tr_b16 v[40:41], v5 offset:8192
    ds_read_b64_tr_b16 v[42:43], v5 offset:8704
    s_waitcnt lgkmcnt(4)
    buffer_store_dwordx4 v[32:35], v6, s[36:39], s32 offen offset:0 nt
    s_waitcnt lgkmcnt(2)
    buffer_store_dwordx4 v[36:39], v6, s[36:39], s32 offen offset:64 nt
    s_waitcnt lgkmcnt(0)
    s_mov_b32 exec_hi, 0
    buffer_store_dwordx4 v[40:43], v6, s[36:39], s32 offen offset:128 nt
    s_mov_b64 exec, -1
    s_sub_u32 s32, s32, 40960
    s_waitcnt lgkmcnt(0)
    s_mov_b64 exec, 1
    ds_add_u32 v10, v144
    s_mov_b64 exec, -1
L_cv_spin_27:
    ds_read_b32 v13, v10
    s_waitcnt lgkmcnt(0)
    v_readfirstlane_b32 s19, v13
    s_cmp_ge_u32 s19, 20
    s_cbranch_scc1 L_cv_ok_28
    s_sleep 1
    s_branch L_cv_spin_27
L_cv_ok_28:
    s_waitcnt vmcnt(5)
    ds_write_b128 v7, v[44:47] offset:0
    s_waitcnt vmcnt(4)
    ds_write_b128 v7, v[48:51] offset:4096
    s_mov_b64 exec, s[28:29]
    s_waitcnt vmcnt(3)
    ds_write_b128 v7, v[52:55] offset:8192
    s_mov_b64 exec, -1
    s_waitcnt lgkmcnt(0)
    s_mov_b64 exec, 1
    ds_add_u32 v10, v144
    s_mov_b64 exec, -1
L_cv_spin_29:
    ds_read_b32 v13, v10
    s_waitcnt lgkmcnt(0)
    v_readfirstlane_b32 s19, v13
    s_cmp_ge_u32 s19, 24
    s_cbranch_scc1 L_cv_ok_30
    s_sleep 1
    s_branch L_cv_spin_29
L_cv_ok_30:
    ds_read_b64_tr_b16 v[44:45], v5 offset:0
    ds_read_b64_tr_b16 v[46:47], v5 offset:512
    ds_read_b64_tr_b16 v[48:49], v5 offset:4096
    ds_read_b64_tr_b16 v[50:51], v5 offset:4608
    ds_read_b64_tr_b16 v[52:53], v5 offset:8192
    ds_read_b64_tr_b16 v[54:55], v5 offset:8704
    s_waitcnt lgkmcnt(4)
    buffer_store_dwordx4 v[44:47], v6, s[36:39], s32 offen offset:0 nt
    s_waitcnt lgkmcnt(2)
    buffer_store_dwordx4 v[48:51], v6, s[36:39], s32 offen offset:64 nt
    s_waitcnt lgkmcnt(0)
    s_mov_b32 exec_hi, 0
    buffer_store_dwordx4 v[52:55], v6, s[36:39], s32 offen offset:128 nt
    s_mov_b64 exec, -1
L_noy:
    s_mul_i32 s20, s17, 5120
    s_add_u32 m0, s20, 102400
L_cv_spin_31:
    ds_read_b32 v13, v10 offset:28
    s_waitcnt lgkmcnt(0)
    v_readfirstlane_b32 s19, v13
    s_cmp_ge_u32 s19, 8
    s_cbranch_scc1 L_cv_ok_32
    s_sleep 4
    s_branch L_cv_spin_31
L_cv_ok_32:
    buffer_load_dwordx4 v17, s[12:15], s23 offen offset:0  lds
    s_add_u32 m0, m0, 992
    s_nop 0
    buffer_load_dwordx4 v17, s[12:15], s23 offen offset:32  lds
    s_add_u32 m0, m0, 992
    s_nop 0
    buffer_load_dwordx4 v17, s[12:15], s23 offen offset:64  lds
    s_add_u32 m0, m0, 992
    s_nop 0
    buffer_load_dwordx4 v17, s[12:15], s23 offen offset:96  lds
    s_add_u32 m0, m0, 992
    s_nop 0
    buffer_load_dwordx4 v17, s[12:15], s23 offen offset:128  lds
    s_add_u32 m0, m0, 1152
    s_waitcnt vmcnt(0)
    s_mov_b64 exec, 1
    ds_add_u32 v10, v144 offset:16
    s_mov_b64 exec, -1
    s_waitcnt lgkmcnt(0)
    s_branch L_attn_kernel_done
L_p2_attn:
    s_lshr_b32 s19, s2, 5
    s_lshl_b32 s19, s19, 3
    s_add_u32 s17, s19, s3
    v_lshlrev_b32 v2, 4, v1
    v_and_b32 v6, 31, v1
    v_lshlrev_b32 v7, 4, v6
    s_mul_i32 s19, s16, 81920
    s_lshr_b32 s20, s17, 1
    s_mul_i32 s20, s20, 2560
    s_add_u32 s19, s19, s20
    s_add_u32 s19, s19, 5242880
    s_and_b32 s20, s17, 1
    s_lshl3_add_u32 s21, s20, s19
    s_lshl_b32 s20, s20, 10
    s_add_u32 s20, s20, s19
    s_mov_b32 s10, 7864320
    s_mov_b32 s11, 0x00020000
    s_waitcnt lgkmcnt(0)
    s_mov_b64 s[8:9], s[4:5]
    buffer_load_dwordx4 v[12:15], v2, s[8:11], s20 offen
    buffer_load_dwordx2 v[16:17], v7, s[8:11], s21 offen offset:2048
    s_add_u32 s12, s4, 7864320
    s_addc_u32 s13, s5, 0
    s_mov_b32 s14, 2629632
    s_mov_b32 s15, 0x00020000
    s_mov_b32 s26, 0x000fffff
    s_mov_b32 s27, 0x000fffff
    s_movk_i32 s25, 20480
    v_lshlrev_b32 v5, 4, v1
    s_mul_i32 s36, s17, 40960
    s_mul_i32 s19, s16, 1280
    s_add_u32 s36, s36, s19
    s_lshr_b32 s58, s2, 4
    s_and_b32 s58, s58, 2
    s_xor_b32 s58, s58, s16
    s_bfe_u32 s19, s3, 0x10001
    s_lshl1_add_u32 s19, s58, s19
    s_mul_i32 s48, s19, 40960
    s_cmp_lt_u32 s3, 4
    s_cselect_b32 s19, 0, 0
    s_add_u32 s21, s48, s19
    s_lshr_b32 s20, s2, 5
    s_and_b32 s19, s3, 4
    s_xor_b32 s20, s20, s19
    s_xor_b32 s19, s20, 0
    s_mul_i32 s19, s19, 5120
    s_add_u32 s52, s21, s19
    s_add_u32 s48, s52, 2560
    s_xor_b32 s19, s20, 1
    s_mul_i32 s19, s19, 5120
    s_add_u32 s53, s21, s19
    s_add_u32 s49, s53, 2560
    s_xor_b32 s19, s20, 2
    s_mul_i32 s19, s19, 5120
    s_add_u32 s54, s21, s19
    s_add_u32 s50, s54, 2560
    s_xor_b32 s19, s20, 3
    s_mul_i32 s19, s19, 5120
    s_add_u32 s55, s21, s19
    s_add_u32 s51, s55, 2560
    s_and_b32 s19, s20, 4
    s_mul_i32 s19, s19, 5120
    s_add_u32 s57, s21, s19
    s_add_u32 s56, s57, 2560
    s_and_b32 s20, s20, 3
    s_and_b32 s19, s3, 1
    s_lshl_b32 s19, s19, 4
    v_and_b32 v9, 15, v1
    v_add_u32 v9, s19, v9
    v_lshrrev_b32 v8, 5, v1
    v_mul_u32_u24 v18, 1280, v8
    v_bfe_u32 v8, v1, 4, 1
    v_lshl_add_u32 v18, v8, 9, v18
    v_lshl_add_u32 v18, v9, 4, v18
    v_lshrrev_b32 v8, 4, v1
    v_xor_b32 v8, s20, v8
    v_mul_u32_u24 v19, 5120, v8
    v_lshl_add_u32 v19, v9, 3, v19
    v_and_b32 v9, 27, v1
    v_cmp_eq_u32 vcc, 24, v9
    v_mov_b32 v9, 0x3f803f80
    v_cndmask_b32 v9, 0, v9, vcc
    v_mov_b32 v32, v9
    v_mov_b32 v33, v9
    v_mov_b32 v34, v9
    v_mov_b32 v35, v9
    v_mov_b32 v36, v9
    v_mov_b32 v37, v9
    v_mov_b32 v38, v9
    v_mov_b32 v39, v9
    v_mov_b32 v40, v9
    v_mov_b32 v41, v9
    v_mov_b32 v42, v9
    v_mov_b32 v43, v9
    v_mov_b32 v44, v9
    v_mov_b32 v45, v9
    v_mov_b32 v46, v9
    v_mov_b32 v47, v9
    v_mov_b32 v64, -1
    v_mov_b32 v65, -1
    v_mov_b32 v66, -1
    v_mov_b32 v67, -1
    v_mov_b32 v68, -1
    v_mov_b32 v69, -1
    v_mov_b32 v70, -1
    v_mov_b32 v71, -1
    v_mov_b32 v72, -1
    v_mov_b32 v73, -1
    v_mov_b32 v74, -1
    v_mov_b32 v75, -1
    v_mov_b32 v76, -1
    v_mov_b32 v77, -1
    v_mov_b32 v78, -1
    v_mov_b32 v79, -1
    s_mov_b32 s22, 0x07060302
    v_lshlrev_b32 v9, 3, v1
    v_lshlrev_b32 v2, 4, v1
    v_lshrrev_b32 v8, 5, v1
    v_mul_u32_u24 v4, 320, v8
    v_and_b32 v6, 31, v1
    v_lshlrev_b32 v3, 3, v8
    v_lshl_add_u32 v3, v6, 4, v3
    v_add_u32 v3, 2048, v3
    v_lshl_add_u32 v4, v6, 4, v4
    v_add_u32 v4, 2560, v4
    v_mov_b32 v80, 0
    v_mov_b32 v81, 0
    v_mov_b32 v82, 0
    v_mov_b32 v83, 0
    v_mov_b32 v84, 0
    v_mov_b32 v85, 0
    v_mov_b32 v86, 0
    v_mov_b32 v87, 0
    v_mov_b32 v88, 0
    v_mov_b32 v89, 0
    v_mov_b32 v90, 0
    v_mov_b32 v91, 0
    v_mov_b32 v92, 0
    v_mov_b32 v93, 0
    v_mov_b32 v94, 0
    v_mov_b32 v95, 0
    v_mov_b32 v60, 0
    v_mov_b32 v61, 0
    v_mov_b32 v62, 0
    v_mov_b32 v158, 0
    v_mov_b32 v159, 0
    s_mov_b32 s19, 0x3ea52b5c
    s_waitcnt vmcnt(0)
    v_lshlrev_b32 v120, 16, v12
    v_and_b32 v121, 0xffff0000, v12
    v_lshlrev_b32 v122, 16, v13
    v_and_b32 v123, 0xffff0000, v13
    v_lshlrev_b32 v124, 16, v14
    v_and_b32 v125, 0xffff0000, v14
    v_lshlrev_b32 v126, 16, v15
    v_and_b32 v127, 0xffff0000, v15
    v_lshlrev_b32 v128, 16, v16
    v_and_b32 v129, 0xffff0000, v16
    v_lshlrev_b32 v130, 16, v17
    v_and_b32 v131, 0xffff0000, v17
    v_mul_f32 v120, s19, v120
    v_mul_f32 v121, s19, v121
    v_mul_f32 v122, s19, v122
    v_mul_f32 v123, s19, v123
    v_mul_f32 v124, s19, v124
    v_mul_f32 v125, s19, v125
    v_mul_f32 v126, s19, v126
    v_mul_f32 v127, s19, v127
    v_mul_f32 v128, s19, v128
    v_mul_f32 v129, s19, v129
    v_mul_f32 v130, s19, v130
    v_mul_f32 v131, s19, v131
    v_cvt_pk_bf16_f32 v12, v120, v121
    v_cvt_pk_bf16_f32 v13, v122, v123
    v_cvt_pk_bf16_f32 v14, v124, v125
    v_cvt_pk_bf16_f32 v15, v126, v127
    v_cvt_pk_bf16_f32 v16, v128, v129
    v_cvt_pk_bf16_f32 v17, v130, v131
    s_barrier
L_at_start_33:
    ds_read_b128 v[20:23], v2 offset:0
    ds_read_b128 v[24:27], v2 offset:1024
    ds_read_b64 v[28:29], v3 offset:0
    s_mov_b64 exec, s[26:27]
    ds_read_b128 v[32:35], v4 offset:0
    ds_read_b128 v[36:39], v4 offset:640
    s_mov_b64 exec, -1
    s_waitcnt lgkmcnt(2)
    v_mfma_f32_32x32x16_bf16 v[96:111], v[20:23], v[12:15], 0
    v_mfma_f32_32x32x16_bf16 v[112:127], v[24:27], v[12:15], 0
    ds_read_b128 v[20:23], v2 offset:5120
    ds_read_b128 v[24:27], v2 offset:6144
    s_nop 7
    v_mfma_f32_32x32x4_2b_bf16 v[96:127], v[28:29], v[16:17], v[96:127]
    ds_read_b64 v[28:29], v3 offset:5120
    s_mov_b32 s23, 0
    s_nop 15
    s_waitcnt lgkmcnt(0)
    s_branch L_at_body_35
L_at_bar_36:
    s_lshl_b32 s20, s23, 2
    s_add_u32 s20, s20, 151088
    v_mov_b32 v6, s20
    s_cmp_eq_u32 s23, 1
    s_cbranch_scc1 L_at_spin_38
    v_mov_b32 v7, 1
    s_mov_b64 exec, 1
    ds_add_u32 v6, v7 offset:4
    s_mov_b64 exec, -1
    s_cmp_eq_u32 s23, 6
    s_cbranch_scc1 L_at_body_35
L_at_spin_38:
    ds_read_b32 v7, v6
    s_waitcnt lgkmcnt(0)
    v_readfirstlane_b32 s19, v7
    s_cmp_ge_u32 s19, 4
    s_cbranch_scc1 L_at_body_35
    s_sleep 2
    s_branch L_at_spin_38
    .p2align 6
L_at_loop_34:
    s_bitcmp1_b32 s28, s23
    s_cbranch_scc1 L_at_bar_36
L_at_body_35:
    s_cmp_eq_u32 s23, 5
    s_cselect_b32 s24, -102400, s25
    v_mfma_f32_32x32x16_bf16 v[128:143], v[20:23], v[12:15], 0
    ds_read_b128 v[20:23], v2 offset:10240
    s_setprio 3
    v_exp_f32 v96, v96
    v_exp_f32 v97, v97
    v_cvt_pk_bf16_f32 v63, v158, v159
    v_exp_f32 v98, v98
    v_exp_f32 v99, v99
    v_cvt_pk_bf16_f32 v48, v96, v97
    s_waitcnt lgkmcnt(5)
    v_mfma_f32_32x32x16_bf16 v[80:95], v[44:47], v[60:63], v[80:95]
    s_mov_b64 exec, s[26:27]
    ds_read_b128 v[40:43], v4 offset:1280
    ds_read_b128 v[44:47], v4 offset:1920
    s_mov_b64 exec, -1
    v_exp_f32 v100, v100
    v_exp_f32 v101, v101
    v_cvt_pk_bf16_f32 v49, v98, v99
    v_exp_f32 v102, v102
    v_exp_f32 v103, v103
    v_cvt_pk_bf16_f32 v50, v100, v101
    s_waitcnt lgkmcnt(6)
    v_mfma_f32_32x32x16_bf16 v[144:159], v[24:27], v[12:15], 0
    ds_read_b128 v[24:27], v2 offset:11264
    v_exp_f32 v104, v104
    v_exp_f32 v105, v105
    v_cvt_pk_bf16_f32 v51, v102, v103
    v_exp_f32 v106, v106
    v_exp_f32 v107, v107
    v_cvt_pk_bf16_f32 v52, v104, v105
    s_waitcnt lgkmcnt(5)
    v_mfma_f32_32x32x16_bf16 v[80:95], v[32:35], v[48:51], v[80:95]
    v_exp_f32 v108, v108
    v_exp_f32 v109, v109
    v_cvt_pk_bf16_f32 v53, v106, v107
    v_exp_f32 v110, v110
    v_exp_f32 v111, v111
    v_cvt_pk_bf16_f32 v54, v108, v109
    v_mfma_f32_32x32x4_2b_bf16 v[128:159], v[28:29], v[16:17], v[128:159]
    ds_read_b64 v[28:29], v3 offset:10240
    v_exp_f32 v112, v112
    v_exp_f32 v113, v113
    v_cvt_pk_bf16_f32 v55, v110, v111
    v_exp_f32 v114, v114
    v_exp_f32 v115, v115
    v_cvt_pk_bf16_f32 v56, v112, v113
    v_exp_f32 v116, v116
    v_exp_f32 v117, v117
    v_cvt_pk_bf16_f32 v57, v114, v115
    v_exp_f32 v118, v118
    v_exp_f32 v119, v119
    v_cvt_pk_bf16_f32 v58, v116, v117
    s_waitcnt lgkmcnt(5)
    v_mfma_f32_32x32x16_bf16 v[80:95], v[36:39], v[52:55], v[80:95]
    s_mov_b64 exec, s[26:27]
    ds_read_b128 v[32:35], v4 offset:5120
    ds_read_b128 v[36:39], v4 offset:5760
    s_mov_b64 exec, -1
    v_exp_f32 v120, v120
    v_exp_f32 v121, v121
    v_cvt_pk_bf16_f32 v59, v118, v119
    v_exp_f32 v122, v122
    v_exp_f32 v123, v123
    v_cvt_pk_bf16_f32 v60, v120, v121
    s_waitcnt lgkmcnt(5)
    v_mfma_f32_32x32x16_bf16 v[80:95], v[40:43], v[56:59], v[80:95]
    v_exp_f32 v124, v124
    v_exp_f32 v125, v125
    v_cvt_pk_bf16_f32 v61, v122, v123
    v_exp_f32 v126, v126
    v_exp_f32 v127, v127
    v_cvt_pk_bf16_f32 v62, v124, v125
    v_mfma_f32_32x32x16_bf16 v[96:111], v[20:23], v[12:15], 0
    ds_read_b128 v[20:23], v2 offset:15360
    v_exp_f32 v128, v128
    v_exp_f32 v129, v129
    v_cvt_pk_bf16_f32 v63, v126, v127
    v_exp_f32 v130, v130
    v_exp_f32 v131, v131
    v_cvt_pk_bf16_f32 v48, v128, v129
    s_waitcnt lgkmcnt(5)
    v_mfma_f32_32x32x16_bf16 v[80:95], v[44:47], v[60:63], v[80:95]
    s_mov_b64 exec, s[26:27]
    ds_read_b128 v[40:43], v4 offset:6400
    ds_read_b128 v[44:47], v4 offset:7040
    s_mov_b64 exec, -1
    v_exp_f32 v132, v132
    v_exp_f32 v133, v133
    v_cvt_pk_bf16_f32 v49, v130, v131
    v_exp_f32 v134, v134
    v_exp_f32 v135, v135
    v_cvt_pk_bf16_f32 v50, v132, v133
    s_waitcnt lgkmcnt(6)
    v_mfma_f32_32x32x16_bf16 v[112:127], v[24:27], v[12:15], 0
    ds_read_b128 v[24:27], v2 offset:16384
    s_setprio 2
    v_exp_f32 v136, v136
    v_exp_f32 v137, v137
    v_cvt_pk_bf16_f32 v51, v134, v135
    v_add_u32 v2, s24, v2
    v_exp_f32 v138, v138
    v_exp_f32 v139, v139
    v_cvt_pk_bf16_f32 v52, v136, v137
    s_waitcnt lgkmcnt(5)
    v_mfma_f32_32x32x16_bf16 v[80:95], v[32:35], v[48:51], v[80:95]
    v_exp_f32 v140, v140
    v_exp_f32 v141, v141
    v_cvt_pk_bf16_f32 v53, v138, v139
    v_exp_f32 v142, v142
    v_exp_f32 v143, v143
    v_cvt_pk_bf16_f32 v54, v140, v141
    v_mfma_f32_32x32x4_2b_bf16 v[96:127], v[28:29], v[16:17], v[96:127]
    ds_read_b64 v[28:29], v3 offset:15360
    v_exp_f32 v144, v144
    v_exp_f32 v145, v145
    v_cvt_pk_bf16_f32 v55, v142, v143
    v_exp_f32 v146, v146
    v_exp_f32 v147, v147
    v_cvt_pk_bf16_f32 v56, v144, v145
    v_add_u32 v3, s24, v3
    v_exp_f32 v148, v148
    v_exp_f32 v149, v149
    v_cvt_pk_bf16_f32 v57, v146, v147
    v_exp_f32 v150, v150
    v_exp_f32 v151, v151
    v_cvt_pk_bf16_f32 v58, v148, v149
    s_waitcnt lgkmcnt(5)
    v_mfma_f32_32x32x16_bf16 v[80:95], v[36:39], v[52:55], v[80:95]
    s_mov_b64 exec, s[26:27]
    ds_read_b128 v[32:35], v4 offset:10240
    ds_read_b128 v[36:39], v4 offset:10880
    s_mov_b64 exec, -1
    v_exp_f32 v152, v152
    v_exp_f32 v153, v153
    v_cvt_pk_bf16_f32 v59, v150, v151
    v_exp_f32 v154, v154
    v_exp_f32 v155, v155
    v_cvt_pk_bf16_f32 v60, v152, v153
    s_waitcnt lgkmcnt(5)
    v_mfma_f32_32x32x16_bf16 v[80:95], v[40:43], v[56:59], v[80:95]
    v_exp_f32 v156, v156
    v_exp_f32 v157, v157
    v_cvt_pk_bf16_f32 v61, v154, v155
    v_exp_f32 v158, v158
    v_exp_f32 v159, v159
    v_cvt_pk_bf16_f32 v62, v156, v157
    v_mfma_f32_32x32x16_bf16 v[128:143], v[20:23], v[12:15], 0
    ds_read_b128 v[20:23], v2 offset:0
    v_exp_f32 v96, v96
    v_exp_f32 v97, v97
    v_cvt_pk_bf16_f32 v63, v158, v159
    v_exp_f32 v98, v98
    v_exp_f32 v99, v99
    v_cvt_pk_bf16_f32 v48, v96, v97
    s_waitcnt lgkmcnt(5)
    v_mfma_f32_32x32x16_bf16 v[80:95], v[44:47], v[60:63], v[80:95]
    s_mov_b64 exec, s[26:27]
    ds_read_b128 v[40:43], v4 offset:11520
    ds_read_b128 v[44:47], v4 offset:12160
    s_mov_b64 exec, -1
    v_exp_f32 v100, v100
    v_exp_f32 v101, v101
    v_cvt_pk_bf16_f32 v49, v98, v99
    v_exp_f32 v102, v102
    v_exp_f32 v103, v103
    v_cvt_pk_bf16_f32 v50, v100, v101
    s_waitcnt lgkmcnt(6)
    v_mfma_f32_32x32x16_bf16 v[144:159], v[24:27], v[12:15], 0
    ds_read_b128 v[24:27], v2 offset:1024
    v_exp_f32 v104, v104
    v_exp_f32 v105, v105
    v_cvt_pk_bf16_f32 v51, v102, v103
    v_exp_f32 v106, v106
    v_exp_f32 v107, v107
    v_cvt_pk_bf16_f32 v52, v104, v105
    s_waitcnt lgkmcnt(5)
    v_mfma_f32_32x32x16_bf16 v[80:95], v[32:35], v[48:51], v[80:95]
    s_setprio 1
    v_exp_f32 v108, v108
    v_exp_f32 v109, v109
    v_cvt_pk_bf16_f32 v53, v106, v107
    v_exp_f32 v110, v110
    v_exp_f32 v111, v111
    v_cvt_pk_bf16_f32 v54, v108, v109
    v_mfma_f32_32x32x4_2b_bf16 v[128:159], v[28:29], v[16:17], v[128:159]
    ds_read_b64 v[28:29], v3 offset:0
    v_exp_f32 v112, v112
    v_exp_f32 v113, v113
    v_cvt_pk_bf16_f32 v55, v110, v111
    v_exp_f32 v114, v114
    v_exp_f32 v115, v115
    v_cvt_pk_bf16_f32 v56, v112, v113
    v_exp_f32 v116, v116
    v_exp_f32 v117, v117
    v_cvt_pk_bf16_f32 v57, v114, v115
    v_exp_f32 v118, v118
    v_exp_f32 v119, v119
    v_cvt_pk_bf16_f32 v58, v116, v117
    s_waitcnt lgkmcnt(5)
    v_mfma_f32_32x32x16_bf16 v[80:95], v[36:39], v[52:55], v[80:95]
    s_mov_b64 exec, s[26:27]
    ds_read_b128 v[32:35], v4 offset:15360
    ds_read_b128 v[36:39], v4 offset:16000
    s_mov_b64 exec, -1
    v_exp_f32 v120, v120
    v_exp_f32 v121, v121
    v_cvt_pk_bf16_f32 v59, v118, v119
    v_exp_f32 v122, v122
    v_exp_f32 v123, v123
    v_cvt_pk_bf16_f32 v60, v120, v121
    s_waitcnt lgkmcnt(5)
    v_mfma_f32_32x32x16_bf16 v[80:95], v[40:43], v[56:59], v[80:95]
    v_exp_f32 v124, v124
    v_exp_f32 v125, v125
    v_cvt_pk_bf16_f32 v61, v122, v123
    v_exp_f32 v126, v126
    v_exp_f32 v127, v127
    v_cvt_pk_bf16_f32 v62, v124, v125
    v_mfma_f32_32x32x16_bf16 v[96:111], v[20:23], v[12:15], 0
    ds_read_b128 v[20:23], v2 offset:5120
    v_exp_f32 v128, v128
    v_exp_f32 v129, v129
    v_cvt_pk_bf16_f32 v63, v126, v127
    v_exp_f32 v130, v130
    v_exp_f32 v131, v131
    v_cvt_pk_bf16_f32 v48, v128, v129
    s_waitcnt lgkmcnt(5)
    v_mfma_f32_32x32x16_bf16 v[80:95], v[44:47], v[60:63], v[80:95]
    s_mov_b64 exec, s[26:27]
    ds_read_b128 v[40:43], v4 offset:16640
    ds_read_b128 v[44:47], v4 offset:17280
    s_mov_b64 exec, -1
    v_exp_f32 v132, v132
    v_exp_f32 v133, v133
    v_cvt_pk_bf16_f32 v49, v130, v131
    v_exp_f32 v134, v134
    v_exp_f32 v135, v135
    v_cvt_pk_bf16_f32 v50, v132, v133
    s_waitcnt lgkmcnt(6)
    v_mfma_f32_32x32x16_bf16 v[112:127], v[24:27], v[12:15], 0
    ds_read_b128 v[24:27], v2 offset:6144
    v_exp_f32 v136, v136
    v_exp_f32 v137, v137
    v_cvt_pk_bf16_f32 v51, v134, v135
    v_add_u32 v4, s24, v4
    v_exp_f32 v138, v138
    v_exp_f32 v139, v139
    v_cvt_pk_bf16_f32 v52, v136, v137
    s_waitcnt lgkmcnt(5)
    v_mfma_f32_32x32x16_bf16 v[80:95], v[32:35], v[48:51], v[80:95]
    s_setprio 0
    v_exp_f32 v140, v140
    v_exp_f32 v141, v141
    v_cvt_pk_bf16_f32 v53, v138, v139
    v_exp_f32 v142, v142
    v_exp_f32 v143, v143
    v_cvt_pk_bf16_f32 v54, v140, v141
    v_mfma_f32_32x32x4_2b_bf16 v[96:127], v[28:29], v[16:17], v[96:127]
    ds_read_b64 v[28:29], v3 offset:5120
    v_exp_f32 v144, v144
    v_exp_f32 v145, v145
    v_cvt_pk_bf16_f32 v55, v142, v143
    v_exp_f32 v146, v146
    v_exp_f32 v147, v147
    v_cvt_pk_bf16_f32 v56, v144, v145
    v_exp_f32 v148, v148
    v_exp_f32 v149, v149
    v_cvt_pk_bf16_f32 v57, v146, v147
    v_exp_f32 v150, v150
    v_exp_f32 v151, v151
    v_cvt_pk_bf16_f32 v58, v148, v149
    s_waitcnt lgkmcnt(5)
    v_mfma_f32_32x32x16_bf16 v[80:95], v[36:39], v[52:55], v[80:95]
    s_mov_b64 exec, s[26:27]
    ds_read_b128 v[32:35], v4 offset:0
    ds_read_b128 v[36:39], v4 offset:640
    s_mov_b64 exec, -1
    v_exp_f32 v152, v152
    v_exp_f32 v153, v153
    v_cvt_pk_bf16_f32 v59, v150, v151
    v_exp_f32 v154, v154
    v_exp_f32 v155, v155
    v_cvt_pk_bf16_f32 v60, v152, v153
    s_waitcnt lgkmcnt(5)
    v_mfma_f32_32x32x16_bf16 v[80:95], v[40:43], v[56:59], v[80:95]
    v_exp_f32 v156, v156
    v_exp_f32 v157, v157
    v_cvt_pk_bf16_f32 v61, v154, v155
    v_exp_f32 v158, v158
    v_exp_f32 v159, v159
    v_cvt_pk_bf16_f32 v62, v156, v157
    s_add_u32 s23, s23, 1
    s_cmp_lt_u32 s23, 8
    s_cbranch_scc1 L_at_loop_34
    v_cvt_pk_bf16_f32 v63, v158, v159
    s_waitcnt lgkmcnt(0)
    s_nop 0
    v_mfma_f32_32x32x16_bf16 v[80:95], v[44:47], v[60:63], v[80:95]
    s_mov_b32 s19, 0x4e800000
    s_mov_b32 s20, 0x30800000
    s_nop 9
    v_cmp_nge_f32 vcc, s19, v92
    v_cmp_nle_f32 s[30:31], s20, v92
    v_rcp_f32 v6, v92
    s_or_b64 vcc, vcc, s[30:31]
    s_cbranch_scc1 L_at_fb_37
L_at_out_39:
    v_mov_b32 v20, 151088
    ds_read_b32 v21, v20 offset:16
    v_mul_f32 v80, v80, v6
    v_mul_f32 v81, v81, v6
    v_mul_f32 v82, v82, v6
    v_mul_f32 v83, v83, v6
    v_mul_f32 v84, v84, v6
    v_mul_f32 v85, v85, v6
    v_mul_f32 v86, v86, v6
    v_mul_f32 v87, v87, v6
    v_mul_f32 v88, v88, v6
    v_mul_f32 v89, v89, v6
    v_mul_f32 v90, v90, v6
    v_mul_f32 v91, v91, v6
    v_cvt_pk_bf16_f32 v48, v80, v81
    v_cvt_pk_bf16_f32 v49, v82, v83
    v_cvt_pk_bf16_f32 v50, v84, v85
    v_cvt_pk_bf16_f32 v51, v86, v87
    v_cvt_pk_bf16_f32 v52, v88, v89
    v_cvt_pk_bf16_f32 v53, v90, v91
    v_min_u32 v52, -2, v52
    v_min_u32 v53, -2, v53
    v_min_u32 v48, -2, v48
    v_min_u32 v50, -2, v50
    v_min_u32 v49, -2, v49
    v_min_u32 v51, -2, v51
    v_mov_b32_dpp v54, v52 quad_perm:[1,1,3,3] row_mask:0xf bank_mask:0xf
    v_mov_b32_dpp v55, v53 quad_perm:[1,1,3,3] row_mask:0xf bank_mask:0xf
    v_permlane32_swap_b32 v48, v50
    v_permlane32_swap_b32 v49, v51
    buffer_store_dwordx4 v[48:51], v5, s[12:15], s36 offen sc1
    s_mov_b64 exec, 0x55555555
    buffer_store_dwordx4 v[52:55], v9, s[12:15], s36 offen offset:1024 sc1
    s_mov_b64 exec, -1
    v_lshrrev_b32 v7, 5, v1
    v_lshl_add_u32 v6, v7, 8, v9
    s_cmp_lt_u32 s3, 4
    s_cselect_b32 s19, 0, 40960
    s_cselect_b32 s20, 0, 61440
    s_cselect_b32 s21, 0, 10240
    s_add_u32 s19, s19, 40960
    s_add_u32 s20, s20, 61440
    s_add_u32 s21, s21, 102400
    v_add_u32 v12, s19, v6
    v_add_u32 v13, s20, v6
    v_add_u32 v14, s21, v6
L_at_wr_40:
    s_waitcnt lgkmcnt(0)
    v_readfirstlane_b32 s19, v21
    s_cmp_ge_u32 s19, 4
    s_cbranch_scc1 L_at_wo_41
    ds_read_b32 v21, v20 offset:16
    s_branch L_at_wr_40
L_at_wo_41:
    s_barrier
    buffer_load_dwordx4 v[96:99], v18, s[12:15], s48 offen sc1
    buffer_load_dwordx4 v[100:103], v18, s[12:15], s49 offen sc1
    buffer_load_dwordx4 v[104:107], v18, s[12:15], s50 offen sc1
    buffer_load_dwordx4 v[108:111], v18, s[12:15], s51 offen sc1
    buffer_load_dwordx2 v[112:113], v19, s[12:15], s56 offen offset:1024 sc1
    buffer_load_dwordx2 v[114:115], v19, s[12:15], s56 offen offset:2304 sc1
    buffer_load_dwordx4 v[116:119], v18, s[12:15], s52 offen sc1
    ds_read_b64_tr_b16 v[40:41], v12 offset:0
    ds_read_b64_tr_b16 v[42:43], v12 offset:256
    ds_read_b64_tr_b16 v[44:45], v12 offset:1024
    ds_read_b64_tr_b16 v[46:47], v12 offset:1280
    ds_read_b64_tr_b16 v[48:49], v12 offset:2048
    ds_read_b64_tr_b16 v[50:51], v12 offset:2304
    ds_read_b64_tr_b16 v[52:53], v12 offset:3072
    ds_read_b64_tr_b16 v[54:55], v12 offset:3328
    ds_read_b64_tr_b16 v[56:57], v12 offset:4096
    ds_read_b64_tr_b16 v[58:59], v12 offset:4352
    ds_read_b64_tr_b16 v[60:61], v12 offset:5120
    ds_read_b64_tr_b16 v[62:63], v12 offset:5376
    ds_read_b64_tr_b16 v[80:81], v12 offset:6144
    ds_read_b64_tr_b16 v[82:83], v12 offset:6400
    ds_read_b64_tr_b16 v[84:85], v12 offset:7168
    ds_read_b64_tr_b16 v[86:87], v12 offset:7424
    ds_read_b64_tr_b16 v[88:89], v12 offset:8192
    ds_read_b64_tr_b16 v[90:91], v12 offset:8448
    ds_read_b64_tr_b16 v[92:93], v12 offset:9216
    ds_read_b64_tr_b16 v[94:95], v12 offset:9472
    ds_read_b64_tr_b16 v[120:121], v12 offset:10240
    ds_read_b64_tr_b16 v[122:123], v12 offset:10496
    ds_read_b64_tr_b16 v[124:125], v12 offset:11264
    ds_read_b64_tr_b16 v[126:127], v12 offset:11520
    ds_read_b64_tr_b16 v[128:129], v12 offset:12288
    ds_read_b64_tr_b16 v[130:131], v12 offset:12544
    ds_read_b64_tr_b16 v[132:133], v12 offset:13312
    ds_read_b64_tr_b16 v[134:135], v12 offset:13568
    ds_read_b64_tr_b16 v[136:137], v12 offset:14336
    ds_read_b64_tr_b16 v[138:139], v12 offset:14592
    ds_read_b64_tr_b16 v[140:141], v12 offset:15360
    ds_read_b64_tr_b16 v[142:143], v12 offset:15616
    ds_read_b64_tr_b16 v[144:145], v12 offset:16384
    ds_read_b64_tr_b16 v[146:147], v12 offset:16640
    ds_read_b64_tr_b16 v[148:149], v12 offset:17408
    ds_read_b64_tr_b16 v[150:151], v12 offset:17664
    ds_read_b64_tr_b16 v[152:153], v12 offset:18432
    ds_read_b64_tr_b16 v[154:155], v12 offset:18688
    ds_read_b64_tr_b16 v[156:157], v12 offset:19456
    ds_read_b64_tr_b16 v[158:159], v12 offset:19712
    s_and_b32 s21, s3, 3
    s_lshl2_add_u32 s20, s58, s21
    s_mul_i32 s20, s20, 40960
    s_lshr_b32 s19, s2, 5
    s_mul_i32 s19, s19, 160
    s_add_u32 s36, s20, s19
    v_and_b32 v6, 15, v1
    v_mul_u32_u24 v6, 2560, v6
    v_lshl_add_u32 v15, v7, 4, v6
    v_bfe_u32 v7, v1, 4, 1
    v_lshl_add_u32 v16, v7, 3, v15
    v_lshl_add_u32 v15, v7, 5, v15
    s_mul_i32 s21, s21, 5120
    v_add_u32 v5, s21, v5
    s_mov_b32 s8, s44
    s_mov_b32 s9, s45
    s_mov_b32 s10, 5242880
    s_mov_b32 s11, 0x00020000
    s_mov_b32 s24, 131072
    s_cmp_eq_u32 s24, 0
    s_waitcnt vmcnt(6)
L_at_k_82:
    v_max3_u32 v6, v96, v97, v98
    v_max_u32 v6, v6, v99
    v_cmp_eq_u32 vcc, -1, v6
    s_movk_i32 s23, 0
    s_cbranch_vccnz L_at_v_62
L_at_r_72:
    s_waitcnt lgkmcnt(15)
    v_mfma_f32_16x16x32_bf16 v[20:23], v[40:43], v[96:99], 0
    ds_read_b64_tr_b16 v[40:41], v14 offset:0
    ds_read_b64_tr_b16 v[42:43], v14 offset:256
    buffer_load_dwordx4 v[64:67], v18, s[12:15], s53 offen sc1
    v_mfma_f32_16x16x32_bf16 v[24:27], v[44:47], v[96:99], 0
    ds_read_b64_tr_b16 v[44:45], v14 offset:1024
    ds_read_b64_tr_b16 v[46:47], v14 offset:1280
    v_mfma_f32_16x16x32_bf16 v[28:31], v[48:51], v[96:99], 0
    ds_read_b64_tr_b16 v[48:49], v14 offset:2048
    ds_read_b64_tr_b16 v[50:51], v14 offset:2304
    s_cbranch_scc1 L_at_k_83
    s_waitcnt vmcnt(6)
L_at_k_83:
    v_max3_u32 v6, v100, v101, v102
    v_max_u32 v6, v6, v103
    v_cmp_eq_u32 vcc, -1, v6
    s_movk_i32 s23, 1
    v_mfma_f32_16x16x32_bf16 v[32:35], v[52:55], v[96:99], 0
    ds_read_b64_tr_b16 v[52:53], v14 offset:3072
    ds_read_b64_tr_b16 v[54:55], v14 offset:3328
    v_mfma_f32_16x16x32_bf16 v[36:39], v[56:59], v[96:99], 0
    ds_read_b64_tr_b16 v[56:57], v14 offset:4096
    ds_read_b64_tr_b16 v[58:59], v14 offset:4352
    s_cbranch_vccnz L_at_v_63
L_at_r_73:
    s_waitcnt lgkmcnt(15)
    v_mfma_f32_16x16x32_bf16 v[20:23], v[60:63], v[100:103], v[20:23]
    ds_read_b64_tr_b16 v[60:61], v13 offset:0
    ds_read_b64_tr_b16 v[62:63], v13 offset:256
    buffer_load_dwordx4 v[68:71], v18, s[12:15], s54 offen sc1
    v_mfma_f32_16x16x32_bf16 v[24:27], v[80:83], v[100:103], v[24:27]
    ds_read_b64_tr_b16 v[80:81], v13 offset:1024
    ds_read_b64_tr_b16 v[82:83], v13 offset:1280
    v_mfma_f32_16x16x32_bf16 v[28:31], v[84:87], v[100:103], v[28:31]
    ds_read_b64_tr_b16 v[84:85], v13 offset:2048
    ds_read_b64_tr_b16 v[86:87], v13 offset:2304
    s_cbranch_scc1 L_at_k_84
    s_waitcnt vmcnt(6)
L_at_k_84:
    v_max3_u32 v6, v104, v105, v106
    v_max_u32 v6, v6, v107
    v_cmp_eq_u32 vcc, -1, v6
    s_movk_i32 s23, 2
    v_mfma_f32_16x16x32_bf16 v[32:35], v[88:91], v[100:103], v[32:35]
    ds_read_b64_tr_b16 v[88:89], v13 offset:3072
    ds_read_b64_tr_b16 v[90:91], v13 offset:3328
    v_mfma_f32_16x16x32_bf16 v[36:39], v[92:95], v[100:103], v[36:39]
    ds_read_b64_tr_b16 v[92:93], v13 offset:4096
    ds_read_b64_tr_b16 v[94:95], v13 offset:4352
    s_cbranch_vccnz L_at_v_64
L_at_r_74:
    s_waitcnt lgkmcnt(15)
    v_mfma_f32_16x16x32_bf16 v[20:23], v[120:123], v[104:107], v[20:23]
    ds_read_b64_tr_b16 v[120:121], v13 offset:5120
    ds_read_b64_tr_b16 v[122:123], v13 offset:5376
    buffer_load_dwordx4 v[72:75], v18, s[12:15], s55 offen sc1
    v_mfma_f32_16x16x32_bf16 v[24:27], v[124:127], v[104:107], v[24:27]
    ds_read_b64_tr_b16 v[124:125], v13 offset:6144
    ds_read_b64_tr_b16 v[126:127], v13 offset:6400
    v_mfma_f32_16x16x32_bf16 v[28:31], v[128:131], v[104:107], v[28:31]
    ds_read_b64_tr_b16 v[128:129], v13 offset:7168
    ds_read_b64_tr_b16 v[130:131], v13 offset:7424
    s_cbranch_scc1 L_at_k_85
    s_waitcnt vmcnt(6)
L_at_k_85:
    v_max3_u32 v6, v108, v109, v110
    v_max_u32 v6, v6, v111
    v_cmp_eq_u32 vcc, -1, v6
    s_movk_i32 s23, 3
    v_mfma_f32_16x16x32_bf16 v[32:35], v[132:135], v[104:107], v[32:35]
    ds_read_b64_tr_b16 v[132:133], v13 offset:8192
    ds_read_b64_tr_b16 v[134:135], v13 offset:8448
    v_mfma_f32_16x16x32_bf16 v[36:39], v[136:139], v[104:107], v[36:39]
    ds_read_b64_tr_b16 v[136:137], v13 offset:9216
    ds_read_b64_tr_b16 v[138:139], v13 offset:9472
    s_cbranch_vccnz L_at_v_65
L_at_r_75:
    s_waitcnt lgkmcnt(15)
    v_mfma_f32_16x16x32_bf16 v[20:23], v[140:143], v[108:111], v[20:23]
    ds_read_b64_tr_b16 v[140:141], v13 offset:10240
    ds_read_b64_tr_b16 v[142:143], v13 offset:10496
    buffer_load_dwordx2 v[76:77], v19, s[12:15], s57 offen offset:1024 sc1
    buffer_load_dwordx2 v[78:79], v19, s[12:15], s57 offen offset:2304 sc1
    v_mfma_f32_16x16x32_bf16 v[24:27], v[144:147], v[108:111], v[24:27]
    ds_read_b64_tr_b16 v[144:145], v13 offset:11264
    ds_read_b64_tr_b16 v[146:147], v13 offset:11520
    v_mfma_f32_16x16x32_bf16 v[28:31], v[148:151], v[108:111], v[28:31]
    ds_read_b64_tr_b16 v[148:149], v13 offset:12288
    ds_read_b64_tr_b16 v[150:151], v13 offset:12544
    s_cbranch_scc1 L_at_k_86
    s_waitcnt vmcnt(6)
L_at_k_86:
    v_max3_u32 v6, v112, v113, v114
    v_max_u32 v6, v6, v115
    v_cmp_eq_u32 vcc, -1, v6
    s_movk_i32 s23, 4
    v_mfma_f32_16x16x32_bf16 v[32:35], v[152:155], v[108:111], v[32:35]
    ds_read_b64_tr_b16 v[152:153], v13 offset:13312
    ds_read_b64_tr_b16 v[154:155], v13 offset:13568
    v_mfma_f32_16x16x32_bf16 v[36:39], v[156:159], v[108:111], v[36:39]
    ds_read_b64_tr_b16 v[156:157], v13 offset:14336
    ds_read_b64_tr_b16 v[158:159], v13 offset:14592
    s_cbranch_vccnz L_at_v_66
L_at_r_76:
    s_waitcnt lgkmcnt(15)
    v_mfma_f32_16x16x32_bf16 v[20:23], v[40:43], v[112:115], v[20:23]
    ds_read_b64_tr_b16 v[40:41], v13 offset:15360
    ds_read_b64_tr_b16 v[42:43], v13 offset:15616
    v_mfma_f32_16x16x32_bf16 v[24:27], v[44:47], v[112:115], v[24:27]
    ds_read_b64_tr_b16 v[44:45], v13 offset:16384
    ds_read_b64_tr_b16 v[46:47], v13 offset:16640
    v_mfma_f32_16x16x32_bf16 v[28:31], v[48:51], v[112:115], v[28:31]
    ds_read_b64_tr_b16 v[48:49], v13 offset:17408
    ds_read_b64_tr_b16 v[50:51], v13 offset:17664
    s_cbranch_scc1 L_at_k_87
    s_waitcnt vmcnt(5)
L_at_k_87:
    v_max3_u32 v6, v116, v117, v118
    v_max_u32 v6, v6, v119
    v_cmp_eq_u32 vcc, -1, v6
    s_movk_i32 s23, 5
    v_mfma_f32_16x16x32_bf16 v[32:35], v[52:55], v[112:115], v[32:35]
    ds_read_b64_tr_b16 v[52:53], v13 offset:18432
    ds_read_b64_tr_b16 v[54:55], v13 offset:18688
    v_mfma_f32_16x16x32_bf16 v[36:39], v[56:59], v[112:115], v[36:39]
    ds_read_b64_tr_b16 v[56:57], v13 offset:19456
    ds_read_b64_tr_b16 v[58:59], v13 offset:19712
    s_cbranch_vccnz L_at_v_67
L_at_r_77:
    s_waitcnt lgkmcnt(15)
    v_mfma_f32_16x16x32_bf16 v[20:23], v[60:63], v[116:119], v[20:23]
    ds_read_b64_tr_b16 v[60:61], v14 offset:5120
    ds_read_b64_tr_b16 v[62:63], v14 offset:5376
    v_mfma_f32_16x16x32_bf16 v[24:27], v[80:83], v[116:119], v[24:27]
    ds_read_b64_tr_b16 v[80:81], v14 offset:6144
    ds_read_b64_tr_b16 v[82:83], v14 offset:6400
    v_mfma_f32_16x16x32_bf16 v[28:31], v[84:87], v[116:119], v[28:31]
    ds_read_b64_tr_b16 v[84:85], v14 offset:7168
    ds_read_b64_tr_b16 v[86:87], v14 offset:7424
    s_cbranch_scc1 L_at_k_88
    s_waitcnt vmcnt(4)
L_at_k_88:
    v_max3_u32 v6, v64, v65, v66
    v_max_u32 v6, v6, v67
    v_cmp_eq_u32 vcc, -1, v6
    s_movk_i32 s23, 6
    v_mfma_f32_16x16x32_bf16 v[32:35], v[88:91], v[116:119], v[32:35]
    ds_read_b64_tr_b16 v[88:89], v14 offset:8192
    ds_read_b64_tr_b16 v[90:91], v14 offset:8448
    v_mfma_f32_16x16x32_bf16 v[36:39], v[92:95], v[116:119], v[36:39]
    ds_read_b64_tr_b16 v[92:93], v14 offset:9216
    ds_read_b64_tr_b16 v[94:95], v14 offset:9472
    s_cbranch_vccnz L_at_v_68
L_at_r_78:
    s_waitcnt lgkmcnt(15)
    v_mfma_f32_16x16x32_bf16 v[20:23], v[120:123], v[64:67], v[20:23]
    v_mfma_f32_16x16x32_bf16 v[24:27], v[124:127], v[64:67], v[24:27]
    v_mfma_f32_16x16x32_bf16 v[28:31], v[128:131], v[64:67], v[28:31]
    s_cbranch_scc1 L_at_k_89
    s_waitcnt vmcnt(3)
L_at_k_89:
    v_max3_u32 v6, v68, v69, v70
    v_max_u32 v6, v6, v71
    v_cmp_eq_u32 vcc, -1, v6
    s_movk_i32 s23, 7
    v_mfma_f32_16x16x32_bf16 v[32:35], v[132:135], v[64:67], v[32:35]
    v_mfma_f32_16x16x32_bf16 v[36:39], v[136:139], v[64:67], v[36:39]
    s_cbranch_vccnz L_at_v_69
L_at_r_79:
    s_waitcnt lgkmcnt(15)
    v_mfma_f32_16x16x32_bf16 v[20:23], v[140:143], v[68:71], v[20:23]
    v_mfma_f32_16x16x32_bf16 v[24:27], v[144:147], v[68:71], v[24:27]
    v_mfma_f32_16x16x32_bf16 v[28:31], v[148:151], v[68:71], v[28:31]
    s_cbranch_scc1 L_at_k_90
    s_waitcnt vmcnt(2)
L_at_k_90:
    v_max3_u32 v6, v72, v73, v74
    v_max_u32 v6, v6, v75
    v_cmp_eq_u32 vcc, -1, v6
    s_movk_i32 s23, 8
    v_mfma_f32_16x16x32_bf16 v[32:35], v[152:155], v[68:71], v[32:35]
    v_mfma_f32_16x16x32_bf16 v[36:39], v[156:159], v[68:71], v[36:39]
    s_cbranch_vccnz L_at_v_70
L_at_r_80:
    s_waitcnt lgkmcnt(10)
    v_mfma_f32_16x16x32_bf16 v[20:23], v[40:43], v[72:75], v[20:23]
    v_mfma_f32_16x16x32_bf16 v[24:27], v[44:47], v[72:75], v[24:27]
    v_mfma_f32_16x16x32_bf16 v[28:31], v[48:51], v[72:75], v[28:31]
    s_cbranch_scc1 L_at_k_91
    s_waitcnt vmcnt(0)
L_at_k_91:
    v_max3_u32 v6, v76, v77, v78
    v_max_u32 v6, v6, v79
    v_cmp_eq_u32 vcc, -1, v6
    s_movk_i32 s23, 9
    v_mfma_f32_16x16x32_bf16 v[32:35], v[52:55], v[72:75], v[32:35]
    v_mfma_f32_16x16x32_bf16 v[36:39], v[56:59], v[72:75], v[36:39]
    s_cbranch_vccnz L_at_v_71
L_at_r_81:
    s_waitcnt lgkmcnt(0)
    v_mfma_f32_16x16x32_bf16 v[20:23], v[60:63], v[76:79], v[20:23]
    v_mfma_f32_16x16x32_bf16 v[24:27], v[80:83], v[76:79], v[24:27]
    v_mfma_f32_16x16x32_bf16 v[28:31], v[84:87], v[76:79], v[28:31]
    v_mfma_f32_16x16x32_bf16 v[32:35], v[88:91], v[76:79], v[32:35]
    v_mfma_f32_16x16x32_bf16 v[36:39], v[92:95], v[76:79], v[36:39]
L_at_x_93:
    s_cmp_ge_u32 s3, 4
    s_cbranch_scc1 L_at_lo_92
    s_nop 1
    ds_write_b128 v5, v[20:23] offset:0
    ds_write_b128 v5, v[24:27] offset:1024
    ds_write_b128 v5, v[28:31] offset:2048
    ds_write_b128 v5, v[32:35] offset:3072
    s_nop 3
    ds_write_b128 v5, v[36:39] offset:4096
    s_waitcnt lgkmcnt(0)
    s_branch L_attn_kernel_done
L_at_lo_92:
    s_barrier
    ds_read_b128 v[120:123], v5 offset:0
    ds_read_b128 v[124:127], v5 offset:1024
    ds_read_b128 v[128:131], v5 offset:2048
    ds_read_b128 v[132:135], v5 offset:3072
    ds_read_b128 v[136:139], v5 offset:4096
    s_waitcnt lgkmcnt(4)
    v_add_f32 v20, v20, v120
    v_add_f32 v21, v21, v121
    v_add_f32 v22, v22, v122
    v_add_f32 v23, v23, v123
    v_cvt_pk_bf16_f32 v40, v20, v21
    v_cvt_pk_bf16_f32 v41, v22, v23
    s_waitcnt lgkmcnt(3)
    v_add_f32 v24, v24, v124
    v_add_f32 v25, v25, v125
    v_add_f32 v26, v26, v126
    v_add_f32 v27, v27, v127
    v_cvt_pk_bf16_f32 v42, v24, v25
    v_cvt_pk_bf16_f32 v43, v26, v27
    s_waitcnt lgkmcnt(2)
    v_add_f32 v28, v28, v128
    v_add_f32 v29, v29, v129
    v_add_f32 v30, v30, v130
    v_add_f32 v31, v31, v131
    v_permlane16_swap_b32 v40, v42
    v_permlane16_swap_b32 v41, v43
    buffer_store_dwordx4 v[40:43], v15, s[8:11], s36 offen offset:0
    v_cvt_pk_bf16_f32 v44, v28, v29
    v_cvt_pk_bf16_f32 v45, v30, v31
    s_waitcnt lgkmcnt(1)
    v_add_f32 v32, v32, v132
    v_add_f32 v33, v33, v133
    v_add_f32 v34, v34, v134
    v_add_f32 v35, v35, v135
    v_cvt_pk_bf16_f32 v46, v32, v33
    v_cvt_pk_bf16_f32 v47, v34, v35
    s_waitcnt lgkmcnt(0)
    v_add_f32 v36, v36, v136
    v_add_f32 v37, v37, v137
    v_add_f32 v38, v38, v138
    v_add_f32 v39, v39, v139
    v_permlane16_swap_b32 v44, v46
    v_permlane16_swap_b32 v45, v47
    buffer_store_dwordx4 v[44:47], v15, s[8:11], s36 offen offset:64
    v_cvt_pk_bf16_f32 v48, v36, v37
    v_cvt_pk_bf16_f32 v49, v38, v39
    buffer_store_dwordx2 v[48:49], v16, s[8:11], s36 offen offset:128
    s_branch L_attn_kernel_done
L_at_dry:
L_at_v_62:
    s_mov_b64 exec, vcc
    buffer_load_dwordx4 v[96:99], v18, s[12:15], s48 offen sc1
    s_mov_b64 exec, -1
    s_cbranch_scc1 L_at_stub_53
    s_waitcnt vmcnt(1)
    s_cmp_eq_u32 s23, s23
L_at_stub_53:
    v_max3_u32 v6, v100, v101, v102
    v_max_u32 v6, v6, v103
    v_cmp_eq_u32 vcc, -1, v6
L_at_v_63:
    s_mov_b64 exec, vcc
    buffer_load_dwordx4 v[100:103], v18, s[12:15], s49 offen sc1
    s_mov_b64 exec, -1
    s_cbranch_scc1 L_at_stub_54
    s_waitcnt vmcnt(1)
    s_cmp_eq_u32 s23, s23
L_at_stub_54:
    v_max3_u32 v6, v104, v105, v106
    v_max_u32 v6, v6, v107
    v_cmp_eq_u32 vcc, -1, v6
L_at_v_64:
    s_mov_b64 exec, vcc
    buffer_load_dwordx4 v[104:107], v18, s[12:15], s50 offen sc1
    s_mov_b64 exec, -1
    s_cbranch_scc1 L_at_stub_55
    s_waitcnt vmcnt(1)
    s_cmp_eq_u32 s23, s23
L_at_stub_55:
    v_max3_u32 v6, v108, v109, v110
    v_max_u32 v6, v6, v111
    v_cmp_eq_u32 vcc, -1, v6
L_at_v_65:
    s_mov_b64 exec, vcc
    buffer_load_dwordx4 v[108:111], v18, s[12:15], s51 offen sc1
    s_mov_b64 exec, -1
    s_cbranch_scc1 L_at_stub_56
    s_waitcnt vmcnt(1)
    s_cmp_eq_u32 s23, s23
L_at_stub_56:
    v_max3_u32 v6, v112, v113, v114
    v_max_u32 v6, v6, v115
    v_cmp_eq_u32 vcc, -1, v6
L_at_v_66:
    s_mov_b64 exec, vcc
    buffer_load_dwordx2 v[112:113], v19, s[12:15], s56 offen offset:1024 sc1
    buffer_load_dwordx2 v[114:115], v19, s[12:15], s56 offen offset:2304 sc1
    s_mov_b64 exec, -1
    s_cbranch_scc1 L_at_stub_57
    s_waitcnt vmcnt(2)
    s_cmp_eq_u32 s23, s23
L_at_stub_57:
    v_max3_u32 v6, v116, v117, v118
    v_max_u32 v6, v6, v119
    v_cmp_eq_u32 vcc, -1, v6
L_at_v_67:
    s_mov_b64 exec, vcc
    buffer_load_dwordx4 v[116:119], v18, s[12:15], s52 offen sc1
    s_mov_b64 exec, -1
    s_cbranch_scc1 L_at_stub_58
    s_waitcnt vmcnt(1)
    s_cmp_eq_u32 s23, s23
L_at_stub_58:
    v_max3_u32 v6, v64, v65, v66
    v_max_u32 v6, v6, v67
    v_cmp_eq_u32 vcc, -1, v6
L_at_v_68:
    s_mov_b64 exec, vcc
    buffer_load_dwordx4 v[64:67], v18, s[12:15], s53 offen sc1
    s_mov_b64 exec, -1
    s_cbranch_scc1 L_at_stub_59
    s_waitcnt vmcnt(1)
    s_cmp_eq_u32 s23, s23
L_at_stub_59:
    v_max3_u32 v6, v68, v69, v70
    v_max_u32 v6, v6, v71
    v_cmp_eq_u32 vcc, -1, v6
L_at_v_69:
    s_mov_b64 exec, vcc
    buffer_load_dwordx4 v[68:71], v18, s[12:15], s54 offen sc1
    s_mov_b64 exec, -1
    s_cbranch_scc1 L_at_stub_60
    s_waitcnt vmcnt(1)
    s_cmp_eq_u32 s23, s23
L_at_stub_60:
    v_max3_u32 v6, v72, v73, v74
    v_max_u32 v6, v6, v75
    v_cmp_eq_u32 vcc, -1, v6
L_at_v_70:
    s_mov_b64 exec, vcc
    buffer_load_dwordx4 v[72:75], v18, s[12:15], s55 offen sc1
    s_mov_b64 exec, -1
    s_cbranch_scc1 L_at_stub_61
    s_waitcnt vmcnt(1)
    s_cmp_eq_u32 s23, s23
L_at_stub_61:
    v_max3_u32 v6, v76, v77, v78
    v_max_u32 v6, v6, v79
    v_cmp_eq_u32 vcc, -1, v6
L_at_v_71:
    s_mov_b64 exec, vcc
    buffer_load_dwordx2 v[76:77], v19, s[12:15], s57 offen offset:1024 sc1
    buffer_load_dwordx2 v[78:79], v19, s[12:15], s57 offen offset:2304 sc1
    s_mov_b64 exec, -1
    s_sub_u32 s24, s24, 1
    s_cbranch_scc1 L_attn_kernel_done
    s_waitcnt vmcnt(36)
    s_sleep 2
    s_cmp_eq_u32 s23, 9
    s_cbranch_scc0 L_at_chk_51
    v_max3_u32 v6, v76, v77, v78
    v_max_u32 v6, v6, v79
    v_cmp_eq_u32 vcc, -1, v6
    s_cbranch_vccnz L_at_v_71
    s_branch L_at_r_81
L_at_chk_51:
    s_cmp_eq_u32 s23, 8
    s_cbranch_scc0 L_at_chk_50
    v_max3_u32 v6, v72, v73, v74
    v_max_u32 v6, v6, v75
    v_cmp_eq_u32 vcc, -1, v6
    s_cbranch_vccnz L_at_v_70
    s_branch L_at_r_80
L_at_chk_50:
    s_cmp_eq_u32 s23, 7
    s_cbranch_scc0 L_at_chk_49
    v_max3_u32 v6, v68, v69, v70
    v_max_u32 v6, v6, v71
    v_cmp_eq_u32 vcc, -1, v6
    s_cbranch_vccnz L_at_v_69
    s_branch L_at_r_79
L_at_chk_49:
    s_cmp_eq_u32 s23, 6
    s_cbranch_scc0 L_at_chk_48
    v_max3_u32 v6, v64, v65, v66
    v_max_u32 v6, v6, v67
    v_cmp_eq_u32 vcc, -1, v6
    s_cbranch_vccnz L_at_v_68
    s_branch L_at_r_78
L_at_chk_48:
    s_cmp_eq_u32 s23, 5
    s_cbranch_scc0 L_at_chk_47
    v_max3_u32 v6, v116, v117, v118
    v_max_u32 v6, v6, v119
    v_cmp_eq_u32 vcc, -1, v6
    s_cbranch_vccnz L_at_v_67
    s_branch L_at_r_77
L_at_chk_47:
    s_cmp_eq_u32 s23, 4
    s_cbranch_scc0 L_at_chk_46
    v_max3_u32 v6, v112, v113, v114
    v_max_u32 v6, v6, v115
    v_cmp_eq_u32 vcc, -1, v6
    s_cbranch_vccnz L_at_v_66
    s_branch L_at_r_76
L_at_chk_46:
    s_cmp_eq_u32 s23, 3
    s_cbranch_scc0 L_at_chk_45
    v_max3_u32 v6, v108, v109, v110
    v_max_u32 v6, v6, v111
    v_cmp_eq_u32 vcc, -1, v6
    s_cbranch_vccnz L_at_v_65
    s_branch L_at_r_75
L_at_chk_45:
    s_cmp_eq_u32 s23, 2
    s_cbranch_scc0 L_at_chk_44
    v_max3_u32 v6, v104, v105, v106
    v_max_u32 v6, v6, v107
    v_cmp_eq_u32 vcc, -1, v6
    s_cbranch_vccnz L_at_v_64
    s_branch L_at_r_74
L_at_chk_44:
    s_cmp_eq_u32 s23, 1
    s_cbranch_scc0 L_at_chk_43
    v_max3_u32 v6, v100, v101, v102
    v_max_u32 v6, v6, v103
    v_cmp_eq_u32 vcc, -1, v6
    s_cbranch_vccnz L_at_v_63
    s_branch L_at_r_73
L_at_chk_43:
    s_cmp_eq_u32 s23, 0
    s_cbranch_scc0 L_at_chk_42
    v_max3_u32 v6, v96, v97, v98
    v_max_u32 v6, v6, v99
    v_cmp_eq_u32 vcc, -1, v6
    s_cbranch_vccnz L_at_v_62
    s_branch L_at_r_72
L_at_chk_42:
    s_branch L_attn_kernel_done
L_at_fb_37:
    s_waitcnt vmcnt(0)
    v_lshlrev_b32 v2, 4, v1
    v_lshrrev_b32 v8, 5, v1
    v_mul_u32_u24 v4, 320, v8
    v_and_b32 v6, 31, v1
    v_lshlrev_b32 v3, 3, v8
    v_lshl_add_u32 v3, v6, 4, v3
    v_add_u32 v3, 2048, v3
    v_lshl_add_u32 v4, v6, 4, v4
    v_add_u32 v4, 2560, v4
    s_mul_i32 s20, s16, 163840
    s_add_u32 s21, s20, 163840
    v_mov_b32 v10, 0xff800000
L_at_fb1_94:
    buffer_load_dwordx4 v[20:23], v2, s[8:11], s20 offen
    buffer_load_dwordx4 v[24:27], v2, s[8:11], s20 offen offset:1024
    buffer_load_dwordx2 v[28:29], v3, s[8:11], s20 offen
    s_waitcnt vmcnt(0)
    v_mfma_f32_32x32x16_bf16 v[96:111], v[20:23], v[12:15], 0
    v_mfma_f32_32x32x16_bf16 v[112:127], v[24:27], v[12:15], 0
    s_nop 15
    v_mfma_f32_32x32x4_2b_bf16 v[96:127], v[28:29], v[16:17], v[96:127]
    s_nop 15
    s_nop 7
    v_max3_f32 v10, v10, v96, v97
    v_max3_f32 v10, v10, v98, v99
    v_max3_f32 v10, v10, v100, v101
    v_max3_f32 v10, v10, v102, v103
    v_max3_f32 v10, v10, v104, v105
    v_max3_f32 v10, v10, v106, v107
    v_max3_f32 v10, v10, v108, v109
    v_max3_f32 v10, v10, v110, v111
    v_max3_f32 v10, v10, v112, v113
    v_max3_f32 v10, v10, v114, v115
    v_max3_f32 v10, v10, v116, v117
    v_max3_f32 v10, v10, v118, v119
    v_max3_f32 v10, v10, v120, v121
    v_max3_f32 v10, v10, v122, v123
    v_max3_f32 v10, v10, v124, v125
    v_max3_f32 v10, v10, v126, v127
    s_add_u32 s20, s20, 5120
    s_cmp_lt_u32 s20, s21
    s_cbranch_scc1 L_at_fb1_94
    v_mov_b32 v11, v10
    s_nop 1
    v_permlane32_swap_b32 v10, v11
    s_nop 1
    v_max_f32 v10, v10, v11
    v_sub_f32 v64, 0, v10
    v_mov_b32 v80, 0
    v_sub_f32 v65, 0, v10
    v_mov_b32 v81, 0
    v_sub_f32 v66, 0, v10
    v_mov_b32 v82, 0
    v_sub_f32 v67, 0, v10
    v_mov_b32 v83, 0
    v_sub_f32 v68, 0, v10
    v_mov_b32 v84, 0
    v_sub_f32 v69, 0, v10
    v_mov_b32 v85, 0
    v_sub_f32 v70, 0, v10
    v_mov_b32 v86, 0
    v_sub_f32 v71, 0, v10
    v_mov_b32 v87, 0
    v_sub_f32 v72, 0, v10
    v_mov_b32 v88, 0
    v_sub_f32 v73, 0, v10
    v_mov_b32 v89, 0
    v_sub_f32 v74, 0, v10
    v_mov_b32 v90, 0
    v_sub_f32 v75, 0, v10
    v_mov_b32 v91, 0
    v_sub_f32 v76, 0, v10
    v_mov_b32 v92, 0
    v_sub_f32 v77, 0, v10
    v_mov_b32 v93, 0
    v_sub_f32 v78, 0, v10
    v_mov_b32 v94, 0
    v_sub_f32 v79, 0, v10
    v_mov_b32 v95, 0
    s_sub_u32 s20, s21, 163840
L_at_fb2_95:
    buffer_load_dwordx4 v[20:23], v2, s[8:11], s20 offen
    buffer_load_dwordx4 v[24:27], v2, s[8:11], s20 offen offset:1024
    buffer_load_dwordx2 v[28:29], v3, s[8:11], s20 offen
    s_mov_b64 exec, s[26:27]
    buffer_load_dwordx4 v[32:35], v4, s[8:11], s20 offen offset:0
    buffer_load_dwordx4 v[36:39], v4, s[8:11], s20 offen offset:640
    buffer_load_dwordx4 v[40:43], v4, s[8:11], s20 offen offset:1280
    buffer_load_dwordx4 v[44:47], v4, s[8:11], s20 offen offset:1920
    s_mov_b64 exec, -1
    s_waitcnt vmcnt(0)
    v_mfma_f32_32x32x16_bf16 v[96:111], v[20:23], v[12:15], v[64:79]
    v_mfma_f32_32x32x16_bf16 v[112:127], v[24:27], v[12:15], v[64:79]
    s_nop 15
    v_mfma_f32_32x32x4_2b_bf16 v[96:127], v[28:29], v[16:17], v[96:127]
    s_nop 15
    s_nop 7
    v_exp_f32 v96, v96
    v_exp_f32 v97, v97
    v_exp_f32 v98, v98
    v_exp_f32 v99, v99
    v_exp_f32 v100, v100
    v_exp_f32 v101, v101
    v_exp_f32 v102, v102
    v_exp_f32 v103, v103
    v_exp_f32 v104, v104
    v_exp_f32 v105, v105
    v_exp_f32 v106, v106
    v_exp_f32 v107, v107
    v_exp_f32 v108, v108
    v_exp_f32 v109, v109
    v_exp_f32 v110, v110
    v_exp_f32 v111, v111
    v_exp_f32 v112, v112
    v_exp_f32 v113, v113
    v_exp_f32 v114, v114
    v_exp_f32 v115, v115
    v_exp_f32 v116, v116
    v_exp_f32 v117, v117
    v_exp_f32 v118, v118
    v_exp_f32 v119, v119
    v_exp_f32 v120, v120
    v_exp_f32 v121, v121
    v_exp_f32 v122, v122
    v_exp_f32 v123, v123
    v_exp_f32 v124, v124
    v_exp_f32 v125, v125
    v_exp_f32 v126, v126
    v_exp_f32 v127, v127
    s_nop 1
    v_cvt_pk_bf16_f32 v48, v96, v97
    v_cvt_pk_bf16_f32 v49, v98, v99
    v_cvt_pk_bf16_f32 v50, v100, v101
    v_cvt_pk_bf16_f32 v51, v102, v103
    v_cvt_pk_bf16_f32 v52, v104, v105
    v_cvt_pk_bf16_f32 v53, v106, v107
    v_cvt_pk_bf16_f32 v54, v108, v109
    v_cvt_pk_bf16_f32 v55, v110, v111
    v_cvt_pk_bf16_f32 v56, v112, v113
    v_cvt_pk_bf16_f32 v57, v114, v115
    v_cvt_pk_bf16_f32 v58, v116, v117
    v_cvt_pk_bf16_f32 v59, v118, v119
    v_cvt_pk_bf16_f32 v60, v120, v121
    v_cvt_pk_bf16_f32 v61, v122, v123
    v_cvt_pk_bf16_f32 v62, v124, v125
    v_cvt_pk_bf16_f32 v63, v126, v127
    s_nop 3
    v_mfma_f32_32x32x16_bf16 v[80:95], v[32:35], v[48:51], v[80:95]
    v_mfma_f32_32x32x16_bf16 v[80:95], v[36:39], v[52:55], v[80:95]
    v_mfma_f32_32x32x16_bf16 v[80:95], v[40:43], v[56:59], v[80:95]
    v_mfma_f32_32x32x16_bf16 v[80:95], v[44:47], v[60:63], v[80:95]
    s_nop 15
    s_nop 7
    s_add_u32 s20, s20, 5120
    s_cmp_lt_u32 s20, s21
    s_cbranch_scc1 L_at_fb2_95
    v_mov_b32 v64, -1
    v_mov_b32 v65, -1
    v_mov_b32 v66, -1
    v_mov_b32 v67, -1
    v_mov_b32 v68, -1
    v_mov_b32 v69, -1
    v_mov_b32 v70, -1
    v_mov_b32 v71, -1
    v_mov_b32 v72, -1
    v_mov_b32 v73, -1
    v_mov_b32 v74, -1
    v_mov_b32 v75, -1
    v_mov_b32 v76, -1
    v_mov_b32 v77, -1
    v_mov_b32 v78, -1
    v_mov_b32 v79, -1
    v_rcp_f32 v6, v92
    s_nop 1
    s_branch L_at_out_39
L_attn_kernel_done:
L_attn_kernel_done_x:
    s_endpgm
L_attn_kernel_end:
.section .rodata,"a"
.p2align 6
.amdhsa_kernel qkv_kernel
  .amdhsa_next_free_vgpr 178
  .amdhsa_next_free_sgpr 102
  .amdhsa_accum_offset 180
  .amdhsa_group_segment_fixed_size 0
  .amdhsa_kernarg_size 120
  .amdhsa_user_sgpr_count 2
  .amdhsa_user_sgpr_kernarg_segment_ptr 1
  .amdhsa_system_sgpr_workgroup_id_x 1
.end_amdhsa_kernel
.p2align 6
.amdhsa_kernel attn_kernel
  .amdhsa_next_free_vgpr 162
  .amdhsa_next_free_sgpr 102
  .amdhsa_accum_offset 164
  .amdhsa_group_segment_fixed_size 0
  .amdhsa_kernarg_size 120
  .amdhsa_user_sgpr_count 2
  .amdhsa_user_sgpr_kernarg_segment_ptr 1
  .amdhsa_system_sgpr_workgroup_id_x 1
.end_amdhsa_kernel
```
